```python
import torch

def _softmax(x, axis=-1):
    return torch.softmax(x, dim=axis)
def _gelu(x):
    return torch.nn.functional.gelu(x, approximate="tanh")
def _silu(x):
    return torch.nn.functional.silu(x)
def _sigmoid(x):
    return torch.sigmoid(x)
def _layernorm(x, axis=-1, eps=1e-5):
    m = x.mean(dim=axis, keepdim=True)
    v = x.var(dim=axis, keepdim=True, unbiased=False)
    return (x - m) / torch.sqrt(v + eps)
def _scatter_add(tgt, idx, src, axis=0):
    return tgt.clone().index_add_(axis, idx, src)
def _segment_sum(src, seg, n):
    out = torch.zeros((n,) + src.shape[1:], dtype=src.dtype)
    return out.index_add_(0, seg, src)
def _pad(x, pw):
    flat = tuple(v for pair in reversed(pw) for v in pair)
    return torch.nn.functional.pad(x, flat)

kernel_name = 'sequential_preLN__mha_block_cached__glu_gated_geglu__decode'

def setup_inputs():

    _w = (lambda a: (lambda t: t.to(torch.bfloat16) if t.is_floating_point() else t)(torch.as_tensor(a)))
    def _A_setup():
        B, Sq, D = 4, 1, 576
        H, Sk, Dh = 32, 8192, 128
        return {
            "x": _w((lambda *s: torch.randn(*s, dtype=torch.bfloat16) * 0.05)(B, Sq, D)),
            "k_cache": _w((lambda *s: torch.randn(*s, dtype=torch.bfloat16) * 1.6)(B, H, Sk, Dh)),
            "v_cache": _w((lambda *s: torch.randn(*s, dtype=torch.bfloat16) * 0.8)(B, H, Sk, Dh)),
            "wq": _w((lambda *s: torch.randn(*s, dtype=torch.bfloat16) * 1.6)(D, H * Dh) * (D ** -0.5)),
            "wo": _w((lambda *s: torch.randn(*s, dtype=torch.bfloat16) * 0.8)(H * Dh, D) * ((H * Dh) ** -0.5)),
        }
    _A_in = _A_setup()

    def _B_setup():
        B, S, Dm, Df = 4, 1, 576, 4608
        return {
            "x": _w((lambda *s: torch.randn(*s, dtype=torch.bfloat16) * 0.05)(B, S, Dm)),
            "w_gate": _w((lambda *s: torch.randn(*s, dtype=torch.bfloat16) * 0.8)(Dm, Df) * (Dm ** -0.5)),
            "w_up": _w((lambda *s: torch.randn(*s, dtype=torch.bfloat16) * 0.8)(Dm, Df) * (Dm ** -0.5)),
            "w_down": _w((lambda *s: torch.randn(*s, dtype=torch.bfloat16) * 0.8)(Df, Dm) * (Df ** -0.5)),
        }
    _B_in = _B_setup()

    return {
        "A_x": _A_in["x"],
        "A_k_cache": _A_in["k_cache"],
        "A_v_cache": _A_in["v_cache"],
        "A_wq": _A_in["wq"],
        "A_wo": _A_in["wo"],
        "B_x": _B_in["x"],
        "B_w_gate": _B_in["w_gate"],
        "B_w_up": _B_in["w_up"],
        "B_w_down": _B_in["w_down"],
    }

def reference(A_x, A_k_cache, A_v_cache, A_wq, A_wo, B_x, B_w_gate, B_w_up, B_w_down):
    def _A_ref(x, k_cache, v_cache, wq, wo):
        B, Sq, D = x.shape
        H, Dh = 32, 128
        q = (lambda x, *d: x.permute(*d))((x @ wq).reshape(B, Sq, H, Dh), 0, 2, 1, 3)
        scores = torch.einsum("bhqd,bhkd->bhqk", q, k_cache) * (Dh ** -0.5)
        p = _softmax(scores, axis=-1)
        o = torch.einsum("bhqk,bhkd->bhqd", p, v_cache)
        return (lambda x, *d: x.permute(*d))(o, 0, 2, 1, 3).reshape(B, Sq, H * Dh) @ wo

    def _B_ref(x, w_gate, w_up, w_down):
        g = torch.einsum("bsd,df->bsf", x, w_gate)
        u = torch.einsum("bsd,df->bsf", x, w_up)
        h = _gelu(g) * u
        return torch.einsum("bsf,fd->bsd", h, w_down)

    x = A_x
    h = x + _A_ref(_layernorm(x, axis=-1), A_k_cache, A_v_cache, A_wq, A_wo)
    h2 = h + _B_ref(_layernorm(h, axis=-1), B_w_gate, B_w_up, B_w_down)
    return h2
```

```asm
; @launch grid=(256,1,1) block=(512,1,1) lds=143360
.amdgcn_target "amdgcn-amd-amdhsa--gfx950"
.text
.globl sequential_preLN__mha_block_cached__glu_gated_geglu__decode_kernel
.p2align 8
.type sequential_preLN__mha_block_cached__glu_gated_geglu__decode_kernel,@function
sequential_preLN__mha_block_cached__glu_gated_geglu__decode_kernel:
L_code0:
    s_cmp_ge_u32 s2, 256
    s_cbranch_scc1 L_end
    s_load_dwordx16 s[32:47], s[0:1], 0
    s_load_dwordx8 s[48:55], s[0:1], 64
    v_lshrrev_b32 v204, 6, v0
    v_and_b32 v0, 63, v0
    v_readfirstlane_b32 s3, v204
    v_and_b32 v1, 15, v0
    v_lshrrev_b32 v2, 4, v0
    v_lshlrev_b32 v3, 8, v1
    v_lshl_add_u32 v3, v2, 4, v3
    v_lshlrev_b32 v4, 10, v2
    v_lshl_add_u32 v4, v1, 4, v4
    s_mov_b32 s57, s2
    s_lshr_b32 s58, s2, 6
    s_lshr_b32 s59, s2, 1
    s_and_b32 s59, s59, 31
    s_and_b32 s28, s2, 1
    s_lshl_b32 s60, s58, 1
    s_add_u32 s60, s60, s28
    s_and_b32 s29, s2, 7
    s_lshr_b32 s30, s2, 6
    s_lshl_b32 s30, s30, 3
    s_add_u32 s59, s29, s30
    s_bfe_u32 s60, s2, 0x30003
    s_lshr_b32 s58, s60, 1
    s_mov_b32 s61, 2000000
    s_and_b32 s29, s2, 7
    s_lshr_b32 s30, s2, 4
    s_lshl_b32 s31, s30, 3
    s_add_u32 s97, s31, s29
    s_lshr_b32 s31, s30, 1
    s_lshl_b32 s31, s31, 3
    s_add_u32 s31, s31, s29
    s_lshl_b32 s31, s31, 1
    s_and_b32 s4, s30, 1
    s_add_u32 s98, s31, s4
    s_mov_b32 s96, 0
    s_bitcmp1_b32 s2, 3
    s_cbranch_scc1 L_role_done
    s_cmp_lt_u32 s30, 12
    s_cselect_b32 s96, 1, 2
    s_cmp_lt_u32 s30, 14
    s_cbranch_scc1 L_role_done
    s_mov_b32 s96, 0
    s_add_u32 s97, s97, 16
    s_lshl_b32 s31, s29, 1
    s_sub_u32 s4, s30, 14
    s_add_u32 s31, s31, s4
    s_add_u32 s98, s31, 128
L_role_done:
    s_cmp_lt_u32 s30, 12
    s_cselect_b32 s30, 0, 0
    s_and_b32 s28, s60, 1
    s_sub_u32 s5, 256, s30
    s_mov_b32 s4, 0
    s_mov_b32 s6, 0
    s_cmp_eq_u32 s28, 1
    s_cselect_b32 s4, 256, 0
    s_cselect_b32 s5, 512, s5
    s_cselect_b32 s6, s30, 0
    s_mov_b32 s68, 1069066811
    s_mov_b32 s69, 1035273459
    s_mov_b32 s70, 0xffff0000
    s_mov_b32 s95, 4608
    s_waitcnt lgkmcnt(0)
    s_load_dword s56, s[54:55], 0
    s_mov_b32 s8, s34
    s_and_b32 s9, s35, 0xffff
    s_mov_b32 s10, 268435456
    s_mov_b32 s11, 0x00020000
    s_mov_b32 s12, s36
    s_and_b32 s13, s37, 0xffff
    s_mov_b32 s14, 268435456
    s_mov_b32 s15, 0x00020000
    s_mov_b32 s16, s54
    s_and_b32 s17, s55, 0xffff
    s_mov_b32 s18, 4194304
    s_mov_b32 s19, 0x00020000
    s_mov_b32 s20, s32
    s_and_b32 s21, s33, 0xffff
    s_mov_b32 s22, 4608
    s_mov_b32 s23, 0x00020000
    s_mov_b32 s24, s38
    s_and_b32 s25, s39, 0xffff
    s_mov_b32 s26, 4718592
    s_mov_b32 s27, 0x00020000
    s_lshl_b32 s62, s58, 5
    s_add_u32 s62, s62, s59
    s_lshl_b32 s62, s62, 21
    s_lshl_b32 s28, s4, 12
    s_add_u32 s62, s62, s28
    s_sub_u32 s29, s5, s4
    s_lshr_b32 s99, s29, 3
    s_and_b32 s29, s29, 7
    s_mov_b32 s28, s3
    s_and_b32 s28, s28, 7
    s_cmp_lt_u32 s28, s29
    s_addc_u32 s99, s99, 0
    s_cmp_lt_u32 s3, s6
    s_addc_u32 s99, s99, 0
    s_sub_u32 s28, 256, s6
    s_add_u32 s28, s28, s3
    s_lshl_b32 s28, s28, 12
    s_lshl_b32 s101, s58, 5
    s_add_u32 s101, s101, s59
    s_lshl_b32 s101, s101, 21
    s_add_u32 s101, s101, s28
    s_mov_b32 s63, 0
    v_lshlrev_b32 v39, 13, v2
    v_lshl_add_u32 v39, v1, 4, v39
    s_lshl_b32 s30, s3, 15
    s_lshl_b32 s31, s59, 8
    s_add_u32 s30, s30, s31
    s_cmp_lg_u32 s3, 0
    s_cbranch_scc1 L_lq_other
    v_lshlrev_b32 v38, 1, v0
    s_mul_i32 s28, s58, 1152
    buffer_load_ushort v64, v38, s[20:23], s28 offen offset:0 nt
    buffer_load_ushort v65, v38, s[20:23], s28 offen offset:128 nt
    buffer_load_ushort v66, v38, s[20:23], s28 offen offset:256 nt
    buffer_load_ushort v67, v38, s[20:23], s28 offen offset:384 nt
    buffer_load_ushort v68, v38, s[20:23], s28 offen offset:512 nt
    buffer_load_ushort v69, v38, s[20:23], s28 offen offset:640 nt
    buffer_load_ushort v70, v38, s[20:23], s28 offen offset:768 nt
    buffer_load_ushort v71, v38, s[20:23], s28 offen offset:896 nt
    buffer_load_ushort v72, v38, s[20:23], s28 offen offset:1024 nt
    buffer_load_dwordx4 v[160:163], v39, s[24:27], s30 offen nt
    s_add_u32 s30, s30, 262144
    buffer_load_dwordx4 v[164:167], v39, s[24:27], s30 offen nt
    s_add_u32 s30, s30, 262144
    buffer_load_dwordx4 v[168:171], v39, s[24:27], s30 offen nt
    s_add_u32 s30, s30, 262144
    buffer_load_dwordx4 v[172:175], v39, s[24:27], s30 offen nt
    s_add_u32 s30, s30, 262144
    buffer_load_dwordx4 v[176:179], v39, s[24:27], s30 offen nt
    s_add_u32 s30, s30, 262144
    buffer_load_dwordx4 v[180:183], v39, s[24:27], s30 offen nt
    s_add_u32 s30, s30, 262144
    buffer_load_dwordx4 v[184:187], v39, s[24:27], s30 offen nt
    s_add_u32 s30, s30, 262144
    buffer_load_dwordx4 v[188:191], v39, s[24:27], s30 offen nt
    s_add_u32 s30, s30, 262144
    buffer_load_dwordx4 v[192:195], v39, s[24:27], s30 offen nt
    s_add_u32 s30, s30, 262144
    buffer_load_dwordx4 v[196:199], v39, s[24:27], s30 offen nt
    s_add_u32 s30, s30, 262144
    buffer_load_dwordx4 v[200:203], v39, s[24:27], s30 offen nt
    s_add_u32 s30, s30, 262144
    buffer_load_dwordx4 v[204:207], v39, s[24:27], s30 offen nt
    s_add_u32 s30, s30, 262144
    buffer_load_dwordx4 v[208:211], v39, s[24:27], s30 offen nt
    s_add_u32 s30, s30, 262144
    buffer_load_dwordx4 v[212:215], v39, s[24:27], s30 offen nt
    s_add_u32 s30, s30, 262144
    buffer_load_dwordx4 v[216:219], v39, s[24:27], s30 offen nt
    s_add_u32 s30, s30, 262144
    buffer_load_dwordx4 v[220:223], v39, s[24:27], s30 offen nt
    s_add_u32 s30, s30, 262144
    buffer_load_dwordx4 v[224:227], v39, s[24:27], s30 offen nt
    s_add_u32 s30, s30, 262144
    buffer_load_dwordx4 v[228:231], v39, s[24:27], s30 offen nt
    s_branch L_lq_issued
L_lq_other:
    s_lshl_b32 s67, s3, 12
    s_add_u32 s67, s67, s62
    s_cmp_ge_u32 s63, s99
    s_cselect_b32 s67, 268435456, s67
    s_add_u32 s62, s62, 32768
    s_add_u32 s63, s63, 1
    buffer_load_dwordx4 v[64:67], v3, s[8:11], s67 offen offset:0 nt
    buffer_load_dwordx4 v[68:71], v3, s[8:11], s67 offen offset:64 nt
    buffer_load_dwordx4 v[72:75], v3, s[8:11], s67 offen offset:128 nt
    buffer_load_dwordx4 v[76:79], v3, s[8:11], s67 offen offset:192 nt
    buffer_load_dwordx4 v[80:83], v4, s[12:15], s67 offen offset:0 nt
    buffer_load_dwordx4 v[84:87], v4, s[12:15], s67 offen offset:256 nt
    buffer_load_dwordx4 v[88:91], v4, s[12:15], s67 offen offset:512 nt
    buffer_load_dwordx4 v[92:95], v4, s[12:15], s67 offen offset:768 nt
    buffer_load_dwordx4 v[160:163], v39, s[24:27], s30 offen nt
    s_add_u32 s30, s30, 262144
    buffer_load_dwordx4 v[164:167], v39, s[24:27], s30 offen nt
    s_add_u32 s30, s30, 262144
    buffer_load_dwordx4 v[168:171], v39, s[24:27], s30 offen nt
    s_add_u32 s30, s30, 262144
    buffer_load_dwordx4 v[172:175], v39, s[24:27], s30 offen nt
    s_add_u32 s30, s30, 262144
    buffer_load_dwordx4 v[176:179], v39, s[24:27], s30 offen nt
    s_add_u32 s30, s30, 262144
    buffer_load_dwordx4 v[180:183], v39, s[24:27], s30 offen nt
    s_add_u32 s30, s30, 262144
    buffer_load_dwordx4 v[184:187], v39, s[24:27], s30 offen nt
    s_add_u32 s30, s30, 262144
    buffer_load_dwordx4 v[188:191], v39, s[24:27], s30 offen nt
    s_add_u32 s30, s30, 262144
    buffer_load_dwordx4 v[192:195], v39, s[24:27], s30 offen nt
    s_add_u32 s30, s30, 262144
    buffer_load_dwordx4 v[196:199], v39, s[24:27], s30 offen nt
    s_add_u32 s30, s30, 262144
    buffer_load_dwordx4 v[200:203], v39, s[24:27], s30 offen nt
    s_add_u32 s30, s30, 262144
    buffer_load_dwordx4 v[204:207], v39, s[24:27], s30 offen nt
    s_add_u32 s30, s30, 262144
    buffer_load_dwordx4 v[208:211], v39, s[24:27], s30 offen nt
    s_add_u32 s30, s30, 262144
    buffer_load_dwordx4 v[212:215], v39, s[24:27], s30 offen nt
    s_add_u32 s30, s30, 262144
    buffer_load_dwordx4 v[216:219], v39, s[24:27], s30 offen nt
    s_add_u32 s30, s30, 262144
    buffer_load_dwordx4 v[220:223], v39, s[24:27], s30 offen nt
    s_add_u32 s30, s30, 262144
    buffer_load_dwordx4 v[224:227], v39, s[24:27], s30 offen nt
    s_add_u32 s30, s30, 262144
    buffer_load_dwordx4 v[228:231], v39, s[24:27], s30 offen nt
    s_lshl_b32 s67, s3, 12
    s_add_u32 s67, s67, s62
    s_cmp_ge_u32 s63, s99
    s_cselect_b32 s67, 268435456, s67
    s_add_u32 s62, s62, 32768
    s_add_u32 s63, s63, 1
    buffer_load_dwordx4 v[96:99], v3, s[8:11], s67 offen offset:0 nt
    buffer_load_dwordx4 v[100:103], v3, s[8:11], s67 offen offset:64 nt
    buffer_load_dwordx4 v[104:107], v3, s[8:11], s67 offen offset:128 nt
    buffer_load_dwordx4 v[108:111], v3, s[8:11], s67 offen offset:192 nt
    buffer_load_dwordx4 v[112:115], v4, s[12:15], s67 offen offset:0 nt
    buffer_load_dwordx4 v[116:119], v4, s[12:15], s67 offen offset:256 nt
    buffer_load_dwordx4 v[120:123], v4, s[12:15], s67 offen offset:512 nt
    buffer_load_dwordx4 v[124:127], v4, s[12:15], s67 offen offset:768 nt
L_lq_issued:
    v_and_b32 v40, 7, v1
    v_and_b32 v41, 1, v40
    v_lshlrev_b32 v41, 4, v41
    v_mov_b32 v42, 0xffff
    v_lshlrev_b32 v41, v41, v42
    v_lshrrev_b32 v40, 1, v40
    v_mov_b32 v37, 0xff
    v_cmp_eq_u32 vcc, 0, v40
    s_nop 1
    v_cndmask_b32 v5, 0, v41, vcc
    v_cmp_eq_u32 vcc, 1, v40
    s_nop 1
    v_cndmask_b32 v6, 0, v41, vcc
    v_cmp_eq_u32 vcc, 2, v40
    s_nop 1
    v_cndmask_b32 v7, 0, v41, vcc
    v_cmp_eq_u32 vcc, 3, v40
    s_nop 1
    v_cndmask_b32 v8, 0, v41, vcc
    s_waitcnt lgkmcnt(0)
    s_add_u32 s56, s56, 1
    s_and_b32 s28, s56, 0xff
    v_mov_b32 v36, s28
    s_cmp_lg_u32 s3, 0
    s_cbranch_scc1 L_lq_noln
    s_waitcnt vmcnt(18)
    v_lshlrev_b32 v64, 16, v64
    v_lshlrev_b32 v65, 16, v65
    v_lshlrev_b32 v66, 16, v66
    v_lshlrev_b32 v67, 16, v67
    v_lshlrev_b32 v68, 16, v68
    v_lshlrev_b32 v69, 16, v69
    v_lshlrev_b32 v70, 16, v70
    v_lshlrev_b32 v71, 16, v71
    v_lshlrev_b32 v72, 16, v72
    v_add_f32 v84, v64, v65
    v_add_f32 v84, v84, v66
    v_add_f32 v84, v84, v67
    v_add_f32 v84, v84, v68
    v_add_f32 v84, v84, v69
    v_add_f32 v84, v84, v70
    v_add_f32 v84, v84, v71
    v_add_f32 v84, v84, v72
    s_nop 1
    v_add_f32_dpp v84, v84, v84 quad_perm:[1,0,3,2] row_mask:0xf bank_mask:0xf
    s_nop 1
    v_add_f32_dpp v84, v84, v84 quad_perm:[2,3,0,1] row_mask:0xf bank_mask:0xf
    s_nop 1
    v_add_f32_dpp v84, v84, v84 row_half_mirror row_mask:0xf bank_mask:0xf
    s_nop 1
    v_add_f32_dpp v84, v84, v84 row_mirror row_mask:0xf bank_mask:0xf
    s_nop 1
    v_mov_b32 v85, v84
    s_nop 1
    v_permlane16_swap_b32 v84, v85
    s_nop 1
    v_add_f32 v84, v84, v85
    v_mov_b32 v85, v84
    s_nop 1
    v_permlane32_swap_b32 v84, v85
    s_nop 1
    v_add_f32 v84, v84, v85
    v_mul_f32 v84, 987991609, v84
    v_sub_f32 v74, v64, v84
    v_sub_f32 v75, v65, v84
    v_sub_f32 v76, v66, v84
    v_sub_f32 v77, v67, v84
    v_sub_f32 v78, v68, v84
    v_sub_f32 v79, v69, v84
    v_sub_f32 v80, v70, v84
    v_sub_f32 v81, v71, v84
    v_sub_f32 v82, v72, v84
    v_mul_f32 v86, v74, v74
    v_fmac_f32 v86, v75, v75
    v_fmac_f32 v86, v76, v76
    v_fmac_f32 v86, v77, v77
    v_fmac_f32 v86, v78, v78
    v_fmac_f32 v86, v79, v79
    v_fmac_f32 v86, v80, v80
    v_fmac_f32 v86, v81, v81
    v_fmac_f32 v86, v82, v82
    s_nop 1
    v_add_f32_dpp v86, v86, v86 quad_perm:[1,0,3,2] row_mask:0xf bank_mask:0xf
    s_nop 1
    v_add_f32_dpp v86, v86, v86 quad_perm:[2,3,0,1] row_mask:0xf bank_mask:0xf
    s_nop 1
    v_add_f32_dpp v86, v86, v86 row_half_mirror row_mask:0xf bank_mask:0xf
    s_nop 1
    v_add_f32_dpp v86, v86, v86 row_mirror row_mask:0xf bank_mask:0xf
    s_nop 1
    v_mov_b32 v85, v86
    s_nop 1
    v_permlane16_swap_b32 v86, v85
    s_nop 1
    v_add_f32 v86, v86, v85
    v_mov_b32 v85, v86
    s_nop 1
    v_permlane32_swap_b32 v86, v85
    s_nop 1
    v_add_f32 v86, v86, v85
    v_mul_f32 v86, 987991609, v86
    v_cvt_pk_bf16_f32 v85, v84, v86
    v_lshlrev_b32 v84, 16, v85
    v_and_b32 v86, s70, v85
    v_add_f32 v86, 925353388, v86
    v_cvt_pk_bf16_f32 v85, v86, v86
    v_lshlrev_b32 v86, 16, v85
    v_sqrt_f32 v86, v86
    s_nop 0
    v_cvt_pk_bf16_f32 v85, v86, v86
    v_lshlrev_b32 v86, 16, v85
    v_rcp_f32 v87, v86
    v_sub_f32 v74, v64, v84
    v_sub_f32 v75, v65, v84
    v_sub_f32 v76, v66, v84
    v_sub_f32 v77, v67, v84
    v_sub_f32 v78, v68, v84
    v_sub_f32 v79, v69, v84
    v_sub_f32 v80, v70, v84
    v_sub_f32 v81, v71, v84
    v_sub_f32 v82, v72, v84
    v_cvt_pk_bf16_f32 v64, v74, v75
    v_cvt_pk_bf16_f32 v65, v76, v77
    v_cvt_pk_bf16_f32 v66, v78, v79
    v_cvt_pk_bf16_f32 v67, v80, v81
    v_cvt_pk_bf16_f32 v68, v82, v82
    v_lshlrev_b32 v74, 16, v64
    v_and_b32 v75, s70, v64
    v_lshlrev_b32 v76, 16, v65
    v_and_b32 v77, s70, v65
    v_lshlrev_b32 v78, 16, v66
    v_and_b32 v79, s70, v66
    v_lshlrev_b32 v80, 16, v67
    v_and_b32 v81, s70, v67
    v_lshlrev_b32 v82, 16, v68
    v_mul_f32 v64, v74, v87
    v_fma_f32 v88, -v64, v86, v74
    v_fma_f32 v64, v88, v87, v64
    v_mul_f32 v65, v75, v87
    v_fma_f32 v88, -v65, v86, v75
    v_fma_f32 v65, v88, v87, v65
    v_mul_f32 v66, v76, v87
    v_fma_f32 v88, -v66, v86, v76
    v_fma_f32 v66, v88, v87, v66
    v_mul_f32 v67, v77, v87
    v_fma_f32 v88, -v67, v86, v77
    v_fma_f32 v67, v88, v87, v67
    v_mul_f32 v68, v78, v87
    v_fma_f32 v88, -v68, v86, v78
    v_fma_f32 v68, v88, v87, v68
    v_mul_f32 v69, v79, v87
    v_fma_f32 v88, -v69, v86, v79
    v_fma_f32 v69, v88, v87, v69
    v_mul_f32 v70, v80, v87
    v_fma_f32 v88, -v70, v86, v80
    v_fma_f32 v70, v88, v87, v70
    v_mul_f32 v71, v81, v87
    v_fma_f32 v88, -v71, v86, v81
    v_fma_f32 v71, v88, v87, v71
    v_mul_f32 v72, v82, v87
    v_fma_f32 v88, -v72, v86, v82
    v_fma_f32 v72, v88, v87, v72
    v_cvt_pk_bf16_f32 v64, v64, v64
    v_cvt_pk_bf16_f32 v65, v65, v65
    v_cvt_pk_bf16_f32 v66, v66, v66
    v_cvt_pk_bf16_f32 v67, v67, v67
    v_cvt_pk_bf16_f32 v68, v68, v68
    v_cvt_pk_bf16_f32 v69, v69, v69
    v_cvt_pk_bf16_f32 v70, v70, v70
    v_cvt_pk_bf16_f32 v71, v71, v71
    v_cvt_pk_bf16_f32 v72, v72, v72
    v_lshlrev_b32 v88, 2, v0
    ds_write_b32 v88, v64 offset:0
    ds_write_b32 v88, v65 offset:256
    ds_write_b32 v88, v66 offset:512
    ds_write_b32 v88, v67 offset:768
    ds_write_b32 v88, v68 offset:1024
    ds_write_b32 v88, v69 offset:1280
    ds_write_b32 v88, v70 offset:1536
    ds_write_b32 v88, v71 offset:1792
    ds_write_b32 v88, v72 offset:2048
    s_waitcnt lgkmcnt(0)
    s_lshl_b32 s67, s3, 12
    s_add_u32 s67, s67, s62
    s_cmp_ge_u32 s63, s99
    s_cselect_b32 s67, 268435456, s67
    s_add_u32 s62, s62, 32768
    s_add_u32 s63, s63, 1
    buffer_load_dwordx4 v[64:67], v3, s[8:11], s67 offen offset:0 nt
    buffer_load_dwordx4 v[68:71], v3, s[8:11], s67 offen offset:64 nt
    buffer_load_dwordx4 v[72:75], v3, s[8:11], s67 offen offset:128 nt
    buffer_load_dwordx4 v[76:79], v3, s[8:11], s67 offen offset:192 nt
    buffer_load_dwordx4 v[80:83], v4, s[12:15], s67 offen offset:0 nt
    buffer_load_dwordx4 v[84:87], v4, s[12:15], s67 offen offset:256 nt
    buffer_load_dwordx4 v[88:91], v4, s[12:15], s67 offen offset:512 nt
    buffer_load_dwordx4 v[92:95], v4, s[12:15], s67 offen offset:768 nt
L_lq_noln:
    s_barrier
    s_lshl_b32 s28, s3, 4
    v_lshlrev_b32 v38, 2, v2
    v_add_u32 v38, s28, v38
    ds_read_b32 v232, v38 offset:0
    ds_read_b32 v233, v38 offset:128
    ds_read_b32 v234, v38 offset:256
    ds_read_b32 v235, v38 offset:384
    ds_read_b32 v236, v38 offset:512
    ds_read_b32 v237, v38 offset:640
    ds_read_b32 v238, v38 offset:768
    ds_read_b32 v239, v38 offset:896
    ds_read_b32 v240, v38 offset:1024
    s_waitcnt lgkmcnt(0)
    ds_read_b32 v241, v38 offset:1152
    ds_read_b32 v242, v38 offset:1280
    ds_read_b32 v243, v38 offset:1408
    ds_read_b32 v244, v38 offset:1536
    ds_read_b32 v245, v38 offset:1664
    ds_read_b32 v246, v38 offset:1792
    ds_read_b32 v247, v38 offset:1920
    ds_read_b32 v248, v38 offset:2048
    ds_read_b32 v249, v38 offset:2176
    s_cmp_eq_u32 s3, 0
    s_cbranch_scc1 L_lqw0_1
    s_waitcnt vmcnt(8)
    s_branch L_lqwe_2
L_lqw0_1:
    s_waitcnt vmcnt(8)
L_lqwe_2:
    s_waitcnt lgkmcnt(0)
    v_and_b32 v250, v232, v5
    v_and_b32 v251, v232, v6
    v_and_b32 v252, v232, v7
    v_and_b32 v253, v232, v8
    s_nop 1
    v_mfma_f32_16x16x32_bf16 v[16:19], v[250:253], v[160:163], 0
    v_and_b32 v250, v233, v5
    v_and_b32 v251, v233, v6
    v_and_b32 v252, v233, v7
    v_and_b32 v253, v233, v8
    s_nop 1
    v_mfma_f32_16x16x32_bf16 v[16:19], v[250:253], v[164:167], v[16:19]
    v_and_b32 v250, v234, v5
    v_and_b32 v251, v234, v6
    v_and_b32 v252, v234, v7
    v_and_b32 v253, v234, v8
    s_nop 1
    v_mfma_f32_16x16x32_bf16 v[16:19], v[250:253], v[168:171], v[16:19]
    v_and_b32 v250, v235, v5
    v_and_b32 v251, v235, v6
    v_and_b32 v252, v235, v7
    v_and_b32 v253, v235, v8
    s_nop 1
    v_mfma_f32_16x16x32_bf16 v[16:19], v[250:253], v[172:175], v[16:19]
    v_and_b32 v250, v236, v5
    v_and_b32 v251, v236, v6
    v_and_b32 v252, v236, v7
    v_and_b32 v253, v236, v8
    s_nop 1
    v_mfma_f32_16x16x32_bf16 v[16:19], v[250:253], v[176:179], v[16:19]
    v_and_b32 v250, v237, v5
    v_and_b32 v251, v237, v6
    v_and_b32 v252, v237, v7
    v_and_b32 v253, v237, v8
    s_nop 1
    v_mfma_f32_16x16x32_bf16 v[16:19], v[250:253], v[180:183], v[16:19]
    v_and_b32 v250, v238, v5
    v_and_b32 v251, v238, v6
    v_and_b32 v252, v238, v7
    v_and_b32 v253, v238, v8
    s_nop 1
    v_mfma_f32_16x16x32_bf16 v[16:19], v[250:253], v[184:187], v[16:19]
    v_and_b32 v250, v239, v5
    v_and_b32 v251, v239, v6
    v_and_b32 v252, v239, v7
    v_and_b32 v253, v239, v8
    s_nop 1
    v_mfma_f32_16x16x32_bf16 v[16:19], v[250:253], v[188:191], v[16:19]
    v_and_b32 v250, v240, v5
    v_and_b32 v251, v240, v6
    v_and_b32 v252, v240, v7
    v_and_b32 v253, v240, v8
    s_nop 1
    v_mfma_f32_16x16x32_bf16 v[16:19], v[250:253], v[192:195], v[16:19]
    v_and_b32 v250, v241, v5
    v_and_b32 v251, v241, v6
    v_and_b32 v252, v241, v7
    v_and_b32 v253, v241, v8
    s_nop 1
    v_mfma_f32_16x16x32_bf16 v[16:19], v[250:253], v[196:199], v[16:19]
    v_and_b32 v250, v242, v5
    v_and_b32 v251, v242, v6
    v_and_b32 v252, v242, v7
    v_and_b32 v253, v242, v8
    s_nop 1
    v_mfma_f32_16x16x32_bf16 v[16:19], v[250:253], v[200:203], v[16:19]
    v_and_b32 v250, v243, v5
    v_and_b32 v251, v243, v6
    v_and_b32 v252, v243, v7
    v_and_b32 v253, v243, v8
    s_nop 1
    v_mfma_f32_16x16x32_bf16 v[16:19], v[250:253], v[204:207], v[16:19]
    v_and_b32 v250, v244, v5
    v_and_b32 v251, v244, v6
    v_and_b32 v252, v244, v7
    v_and_b32 v253, v244, v8
    s_nop 1
    v_mfma_f32_16x16x32_bf16 v[16:19], v[250:253], v[208:211], v[16:19]
    v_and_b32 v250, v245, v5
    v_and_b32 v251, v245, v6
    v_and_b32 v252, v245, v7
    v_and_b32 v253, v245, v8
    s_nop 1
    v_mfma_f32_16x16x32_bf16 v[16:19], v[250:253], v[212:215], v[16:19]
    v_and_b32 v250, v246, v5
    v_and_b32 v251, v246, v6
    v_and_b32 v252, v246, v7
    v_and_b32 v253, v246, v8
    s_nop 1
    v_mfma_f32_16x16x32_bf16 v[16:19], v[250:253], v[216:219], v[16:19]
    v_and_b32 v250, v247, v5
    v_and_b32 v251, v247, v6
    v_and_b32 v252, v247, v7
    v_and_b32 v253, v247, v8
    s_nop 1
    v_mfma_f32_16x16x32_bf16 v[16:19], v[250:253], v[220:223], v[16:19]
    v_and_b32 v250, v248, v5
    v_and_b32 v251, v248, v6
    v_and_b32 v252, v248, v7
    v_and_b32 v253, v248, v8
    s_nop 1
    v_mfma_f32_16x16x32_bf16 v[16:19], v[250:253], v[224:227], v[16:19]
    v_and_b32 v250, v249, v5
    v_and_b32 v251, v249, v6
    v_and_b32 v252, v249, v7
    v_and_b32 v253, v249, v8
    s_nop 1
    v_mfma_f32_16x16x32_bf16 v[16:19], v[250:253], v[228:231], v[16:19]
    v_lshlrev_b32 v38, 5, v1
    v_and_b32 v39, 1, v2
    v_lshl_add_u32 v38, v39, 4, v38
    s_lshl_b32 s28, s3, 9
    v_add_u32 v38, s28, v38
    s_nop 4
    ds_write_b128 v38, v[16:19] offset:9472
    s_cmp_eq_u32 s3, 0
    s_cbranch_scc1 L_lqr0_3
    s_branch L_lqre_4
L_lqr0_3:
    s_lshl_b32 s67, s3, 12
    s_add_u32 s67, s67, s62
    s_cmp_ge_u32 s63, s99
    s_cselect_b32 s67, 268435456, s67
    s_add_u32 s62, s62, 32768
    s_add_u32 s63, s63, 1
    buffer_load_dwordx4 v[96:99], v3, s[8:11], s67 offen offset:0 nt
    buffer_load_dwordx4 v[100:103], v3, s[8:11], s67 offen offset:64 nt
    buffer_load_dwordx4 v[104:107], v3, s[8:11], s67 offen offset:128 nt
    buffer_load_dwordx4 v[108:111], v3, s[8:11], s67 offen offset:192 nt
    buffer_load_dwordx4 v[112:115], v4, s[12:15], s67 offen offset:0 nt
    buffer_load_dwordx4 v[116:119], v4, s[12:15], s67 offen offset:256 nt
    buffer_load_dwordx4 v[120:123], v4, s[12:15], s67 offen offset:512 nt
    buffer_load_dwordx4 v[124:127], v4, s[12:15], s67 offen offset:768 nt
L_lqre_4:
    s_waitcnt lgkmcnt(0)
    s_barrier
    s_cmp_lg_u32 s3, 1
    s_cbranch_scc1 L_lq_qdone
    v_and_b32 v38, 31, v0
    v_lshlrev_b32 v39, 4, v38
    ds_read_b128 v[232:235], v39 offset:9472
    ds_read_b128 v[236:239], v39 offset:9984
    ds_read_b128 v[240:243], v39 offset:10496
    ds_read_b128 v[244:247], v39 offset:11008
    ds_read_b128 v[176:179], v39 offset:11520
    ds_read_b128 v[180:183], v39 offset:12032
    ds_read_b128 v[184:187], v39 offset:12544
    ds_read_b128 v[188:191], v39 offset:13056
    s_waitcnt lgkmcnt(0)
    v_pk_add_f32 v[232:233], v[232:233], v[236:237]
    v_pk_add_f32 v[240:241], v[240:241], v[244:245]
    v_pk_add_f32 v[176:177], v[176:177], v[180:181]
    v_pk_add_f32 v[184:185], v[184:185], v[188:189]
    v_pk_add_f32 v[234:235], v[234:235], v[238:239]
    v_pk_add_f32 v[242:243], v[242:243], v[246:247]
    v_pk_add_f32 v[178:179], v[178:179], v[182:183]
    v_pk_add_f32 v[186:187], v[186:187], v[190:191]
    v_pk_add_f32 v[232:233], v[232:233], v[240:241]
    v_pk_add_f32 v[176:177], v[176:177], v[184:185]
    v_pk_add_f32 v[234:235], v[234:235], v[242:243]
    v_pk_add_f32 v[178:179], v[178:179], v[186:187]
    v_pk_add_f32 v[232:233], v[232:233], v[176:177]
    v_pk_add_f32 v[234:235], v[234:235], v[178:179]
    v_cvt_pk_bf16_f32 v236, v232, v233
    v_cvt_pk_bf16_f32 v237, v234, v235
    v_lshlrev_b32 v38, 3, v38
    ds_write_b64 v38, v[236:237] offset:9216
    s_waitcnt lgkmcnt(0)
L_lq_qdone:
    s_barrier
    v_lshlrev_b32 v38, 4, v2
L_bare:
    ds_read_b128 v[20:23], v38 offset:9216
    ds_read_b128 v[24:27], v38 offset:9280
    ds_read_b128 v[28:31], v38 offset:9344
    ds_read_b128 v[32:35], v38 offset:9408
    v_mov_b32 v9, 0xff800000
    v_mov_b32 v10, 0
    v_mov_b32 v12, 0
    v_mov_b32 v13, 0
    v_mov_b32 v14, 0
    v_mov_b32 v15, 0
    s_mov_b32 s71, s99
    s_waitcnt lgkmcnt(0)
L_loop:
    s_waitcnt vmcnt(12)
    v_mfma_f32_16x16x32_bf16 v[16:19], v[64:67], v[20:23], 0
    v_mfma_f32_16x16x32_bf16 v[16:19], v[68:71], v[24:27], v[16:19]
    v_mfma_f32_16x16x32_bf16 v[16:19], v[72:75], v[28:31], v[16:19]
    v_mfma_f32_16x16x32_bf16 v[16:19], v[76:79], v[32:35], v[16:19]
    s_lshl_b32 s67, s3, 12
    s_add_u32 s67, s67, s62
    s_cmp_ge_u32 s63, s99
    s_cselect_b32 s67, 268435456, s67
    s_add_u32 s62, s62, 32768
    s_add_u32 s63, s63, 1
    buffer_load_dwordx4 v[64:67], v3, s[8:11], s67 offen offset:0 nt
    buffer_load_dwordx4 v[68:71], v3, s[8:11], s67 offen offset:64 nt
    buffer_load_dwordx4 v[72:75], v3, s[8:11], s67 offen offset:128 nt
    buffer_load_dwordx4 v[76:79], v3, s[8:11], s67 offen offset:192 nt
    s_nop 3
    v_cvt_pk_bf16_f32 v42, v16, v17
    v_cvt_pk_bf16_f32 v43, v18, v19
    v_lshlrev_b32 v38, 16, v42
    v_and_b32 v39, s70, v42
    v_lshlrev_b32 v40, 16, v43
    v_and_b32 v41, s70, v43
    v_mul_f32 v38, s69, v38
    v_mul_f32 v39, s69, v39
    v_mul_f32 v40, s69, v40
    v_mul_f32 v41, s69, v41
    v_cvt_pk_bf16_f32 v42, v38, v39
    v_cvt_pk_bf16_f32 v43, v40, v41
    v_lshlrev_b32 v38, 16, v42
    v_and_b32 v39, s70, v42
    v_lshlrev_b32 v40, 16, v43
    v_and_b32 v41, s70, v43
    v_max3_f32 v44, v38, v39, v40
    v_max3_f32 v44, v44, v41, v9
    v_mov_b32 v45, v44
    s_nop 1
    v_permlane16_swap_b32 v44, v45
    s_nop 1
    v_max_f32 v44, v44, v45
    v_mov_b32 v45, v44
    s_nop 1
    v_permlane32_swap_b32 v44, v45
    s_nop 1
    v_max_f32 v44, v44, v45
    v_sub_f32 v46, v9, v44
    v_mul_f32 v47, s68, v44
    v_mul_f32 v46, s68, v46
    v_fma_f32 v38, v38, s68, -v47
    v_fma_f32 v39, v39, s68, -v47
    v_fma_f32 v40, v40, s68, -v47
    v_fma_f32 v41, v41, s68, -v47
    v_exp_f32 v46, v46
    v_exp_f32 v38, v38
    v_exp_f32 v39, v39
    v_exp_f32 v40, v40
    v_exp_f32 v41, v41
    v_mov_b32 v9, v44
    v_mul_f32 v12, v12, v46
    v_mul_f32 v13, v13, v46
    v_mul_f32 v14, v14, v46
    v_mul_f32 v15, v15, v46
    v_cvt_pk_bf16_f32 v48, v38, v38
    v_cvt_pk_bf16_f32 v49, v39, v39
    v_cvt_pk_bf16_f32 v50, v40, v40
    v_cvt_pk_bf16_f32 v51, v41, v41
    v_fma_f32 v10, v10, v46, v38
    v_add_f32 v39, v39, v40
    v_add_f32 v10, v10, v41
    v_add_f32 v10, v10, v39
    s_waitcnt vmcnt(12)
    v_and_b32 v52, v48, v5
    v_and_b32 v53, v48, v6
    v_and_b32 v54, v48, v7
    v_and_b32 v55, v48, v8
    s_nop 1
    v_mfma_f32_16x16x32_bf16 v[12:15], v[52:55], v[80:83], v[12:15]
    v_and_b32 v56, v49, v5
    v_and_b32 v57, v49, v6
    v_and_b32 v58, v49, v7
    v_and_b32 v59, v49, v8
    s_nop 1
    v_mfma_f32_16x16x32_bf16 v[12:15], v[56:59], v[84:87], v[12:15]
    v_and_b32 v52, v50, v5
    v_and_b32 v53, v50, v6
    v_and_b32 v54, v50, v7
    v_and_b32 v55, v50, v8
    s_nop 1
    v_mfma_f32_16x16x32_bf16 v[12:15], v[52:55], v[88:91], v[12:15]
    v_and_b32 v56, v51, v5
    v_and_b32 v57, v51, v6
    v_and_b32 v58, v51, v7
    v_and_b32 v59, v51, v8
    s_nop 1
    v_mfma_f32_16x16x32_bf16 v[12:15], v[56:59], v[92:95], v[12:15]
    buffer_load_dwordx4 v[80:83], v4, s[12:15], s67 offen offset:0 nt
    buffer_load_dwordx4 v[84:87], v4, s[12:15], s67 offen offset:256 nt
    buffer_load_dwordx4 v[88:91], v4, s[12:15], s67 offen offset:512 nt
    buffer_load_dwordx4 v[92:95], v4, s[12:15], s67 offen offset:768 nt
    s_sub_u32 s71, s71, 1
    s_cmp_eq_u32 s71, 0
    s_cbranch_scc1 L_loop_end
    s_waitcnt vmcnt(12)
    v_mfma_f32_16x16x32_bf16 v[16:19], v[96:99], v[20:23], 0
    v_mfma_f32_16x16x32_bf16 v[16:19], v[100:103], v[24:27], v[16:19]
    v_mfma_f32_16x16x32_bf16 v[16:19], v[104:107], v[28:31], v[16:19]
    v_mfma_f32_16x16x32_bf16 v[16:19], v[108:111], v[32:35], v[16:19]
    s_lshl_b32 s67, s3, 12
    s_add_u32 s67, s67, s62
    s_cmp_ge_u32 s63, s99
    s_cselect_b32 s67, 268435456, s67
    s_add_u32 s62, s62, 32768
    s_add_u32 s63, s63, 1
    buffer_load_dwordx4 v[96:99], v3, s[8:11], s67 offen offset:0 nt
    buffer_load_dwordx4 v[100:103], v3, s[8:11], s67 offen offset:64 nt
    buffer_load_dwordx4 v[104:107], v3, s[8:11], s67 offen offset:128 nt
    buffer_load_dwordx4 v[108:111], v3, s[8:11], s67 offen offset:192 nt
    s_nop 3
    v_cvt_pk_bf16_f32 v42, v16, v17
    v_cvt_pk_bf16_f32 v43, v18, v19
    v_lshlrev_b32 v38, 16, v42
    v_and_b32 v39, s70, v42
    v_lshlrev_b32 v40, 16, v43
    v_and_b32 v41, s70, v43
    v_mul_f32 v38, s69, v38
    v_mul_f32 v39, s69, v39
    v_mul_f32 v40, s69, v40
    v_mul_f32 v41, s69, v41
    v_cvt_pk_bf16_f32 v42, v38, v39
    v_cvt_pk_bf16_f32 v43, v40, v41
    v_lshlrev_b32 v38, 16, v42
    v_and_b32 v39, s70, v42
    v_lshlrev_b32 v40, 16, v43
    v_and_b32 v41, s70, v43
    v_max3_f32 v44, v38, v39, v40
    v_max3_f32 v44, v44, v41, v9
    v_mov_b32 v45, v44
    s_nop 1
    v_permlane16_swap_b32 v44, v45
    s_nop 1
    v_max_f32 v44, v44, v45
    v_mov_b32 v45, v44
    s_nop 1
    v_permlane32_swap_b32 v44, v45
    s_nop 1
    v_max_f32 v44, v44, v45
    v_sub_f32 v46, v9, v44
    v_mul_f32 v47, s68, v44
    v_mul_f32 v46, s68, v46
    v_fma_f32 v38, v38, s68, -v47
    v_fma_f32 v39, v39, s68, -v47
    v_fma_f32 v40, v40, s68, -v47
    v_fma_f32 v41, v41, s68, -v47
    v_exp_f32 v46, v46
    v_exp_f32 v38, v38
    v_exp_f32 v39, v39
    v_exp_f32 v40, v40
    v_exp_f32 v41, v41
    v_mov_b32 v9, v44
    v_mul_f32 v12, v12, v46
    v_mul_f32 v13, v13, v46
    v_mul_f32 v14, v14, v46
    v_mul_f32 v15, v15, v46
    v_cvt_pk_bf16_f32 v48, v38, v38
    v_cvt_pk_bf16_f32 v49, v39, v39
    v_cvt_pk_bf16_f32 v50, v40, v40
    v_cvt_pk_bf16_f32 v51, v41, v41
    v_fma_f32 v10, v10, v46, v38
    v_add_f32 v39, v39, v40
    v_add_f32 v10, v10, v41
    v_add_f32 v10, v10, v39
    s_waitcnt vmcnt(12)
    v_and_b32 v52, v48, v5
    v_and_b32 v53, v48, v6
    v_and_b32 v54, v48, v7
    v_and_b32 v55, v48, v8
    s_nop 1
    v_mfma_f32_16x16x32_bf16 v[12:15], v[52:55], v[112:115], v[12:15]
    v_and_b32 v56, v49, v5
    v_and_b32 v57, v49, v6
    v_and_b32 v58, v49, v7
    v_and_b32 v59, v49, v8
    s_nop 1
    v_mfma_f32_16x16x32_bf16 v[12:15], v[56:59], v[116:119], v[12:15]
    v_and_b32 v52, v50, v5
    v_and_b32 v53, v50, v6
    v_and_b32 v54, v50, v7
    v_and_b32 v55, v50, v8
    s_nop 1
    v_mfma_f32_16x16x32_bf16 v[12:15], v[52:55], v[120:123], v[12:15]
    v_and_b32 v56, v51, v5
    v_and_b32 v57, v51, v6
    v_and_b32 v58, v51, v7
    v_and_b32 v59, v51, v8
    s_nop 1
    v_mfma_f32_16x16x32_bf16 v[12:15], v[56:59], v[124:127], v[12:15]
    buffer_load_dwordx4 v[112:115], v4, s[12:15], s67 offen offset:0 nt
    buffer_load_dwordx4 v[116:119], v4, s[12:15], s67 offen offset:256 nt
    buffer_load_dwordx4 v[120:123], v4, s[12:15], s67 offen offset:512 nt
    buffer_load_dwordx4 v[124:127], v4, s[12:15], s67 offen offset:768 nt
    s_sub_u32 s71, s71, 1
    s_cmp_eq_u32 s71, 0
    s_cbranch_scc1 L_loop_end
    s_branch L_loop
L_loop_end:
    v_mov_b32 v38, v10
    s_nop 1
    v_permlane16_swap_b32 v10, v38
    s_nop 1
    v_add_f32 v10, v10, v38
    v_mov_b32 v38, v10
    s_nop 1
    v_permlane32_swap_b32 v10, v38
    s_nop 1
    v_add_f32 v10, v10, v38
    s_nop 7
    v_lshlrev_b32 v38, 5, v1
    v_and_b32 v39, 1, v2
    v_lshl_add_u32 v38, v39, 4, v38
    s_lshl_b32 s28, s3, 9
    v_add_u32 v38, s28, v38
    ds_write_b128 v38, v[12:15] offset:9472
    s_lshl_b32 s28, s3, 3
    v_mov_b32 v40, s28
    v_mov_b32 v42, v9
    v_mov_b32 v43, v10
    ds_write_b64 v40, v[42:43] offset:13568
    s_cmp_ge_u32 s3, 4
    s_cbranch_scc1 L_now
    s_cmp_ge_u32 s3, 2
    s_cbranch_scc1 L_noxr
    s_cmp_eq_u32 s96, 0
    s_cbranch_scc1 L_noxr
    s_mul_i32 s28, s3, 112
    s_add_u32 s28, s28, s97
    s_cmp_ge_u32 s28, 144
    s_cbranch_scc1 L_noxr
    s_mov_b32 s20, s32
    s_and_b32 s21, s33, 0xffff
    s_mov_b32 s22, 4608
    s_mov_b32 s23, 0x00020000
    v_and_b32 v38, 3, v0
    v_lshlrev_b32 v39, 1, v38
    s_lshl_b32 s28, s28, 3
    buffer_load_ushort v160, v39, s[20:23], s28 offen offset:0 nt
    buffer_load_ushort v161, v39, s[20:23], s28 offen offset:1152 nt
    buffer_load_ushort v162, v39, s[20:23], s28 offen offset:2304 nt
    buffer_load_ushort v163, v39, s[20:23], s28 offen offset:3456 nt
L_noxr:
    s_cmp_lg_u32 s96, 0
    s_cbranch_scc1 L_wwo_5
    s_branch L_wdone_6
L_wwo_5:
    s_cmp_eq_u32 s96, 2
    s_cbranch_scc1 L_wdone_6
    s_mov_b32 s29, s97
    s_mul_i32 s30, s29, 21846
    s_lshr_b32 s30, s30, 16
    s_mul_i32 s31, s30, 3
    s_sub_u32 s31, s29, s31
    s_mov_b32 s20, s40
    s_and_b32 s21, s41, 0xffff
    s_mov_b32 s22, 4718592
    s_mov_b32 s23, 0x00020000
    v_add_u32 v41, 0, v0
    v_mul_u32_u24 v42, 2731, v41
    v_lshrrev_b32 v42, 16, v42
    v_mul_u32_u24 v43, 24, v42
    v_sub_u32 v43, v41, v43
    v_mul_u32_u24 v42, 1152, v42
    v_lshl_add_u32 v38, v43, 4, v42
    v_add_u32 v41, 64, v0
    v_mul_u32_u24 v42, 2731, v41
    v_lshrrev_b32 v42, 16, v42
    v_mul_u32_u24 v43, 24, v42
    v_sub_u32 v43, v41, v43
    v_mul_u32_u24 v42, 1152, v42
    v_lshl_add_u32 v39, v43, 4, v42
    v_add_u32 v41, 128, v0
    v_mul_u32_u24 v42, 2731, v41
    v_lshrrev_b32 v42, 16, v42
    v_mul_u32_u24 v43, 24, v42
    v_sub_u32 v43, v41, v43
    v_mul_u32_u24 v42, 1152, v42
    v_lshl_add_u32 v40, v43, 4, v42
    s_lshl_b32 s4, s3, 2
    s_lshl_b32 s28, s30, 7
    s_lshl_b32 s29, s4, 3
    s_add_u32 s28, s28, s29
    s_mul_i32 s28, s28, 1152
    s_mul_i32 s31, s31, 384
    s_add_u32 s28, s28, s31
    s_mul_i32 s31, s4, 3072
    s_add_u32 s5, s28, 0
    s_add_u32 m0, s31, 32768
    s_nop 0
    buffer_load_dwordx4 v38, s[20:23], s5 offen nt lds
    s_add_u32 m0, s31, 33792
    s_nop 0
    buffer_load_dwordx4 v39, s[20:23], s5 offen nt lds
    s_add_u32 m0, s31, 34816
    s_nop 0
    buffer_load_dwordx4 v40, s[20:23], s5 offen nt lds
    s_add_u32 s5, s28, 9216
    s_add_u32 m0, s31, 35840
    s_nop 0
    buffer_load_dwordx4 v38, s[20:23], s5 offen nt lds
    s_add_u32 m0, s31, 36864
    s_nop 0
    buffer_load_dwordx4 v39, s[20:23], s5 offen nt lds
    s_add_u32 m0, s31, 37888
    s_nop 0
    buffer_load_dwordx4 v40, s[20:23], s5 offen nt lds
    s_add_u32 s5, s28, 18432
    s_add_u32 m0, s31, 38912
    s_nop 0
    buffer_load_dwordx4 v38, s[20:23], s5 offen nt lds
    s_add_u32 m0, s31, 39936
    s_nop 0
    buffer_load_dwordx4 v39, s[20:23], s5 offen nt lds
    s_add_u32 m0, s31, 40960
    s_nop 0
    buffer_load_dwordx4 v40, s[20:23], s5 offen nt lds
    s_add_u32 s5, s28, 27648
    s_add_u32 m0, s31, 41984
    s_nop 0
    buffer_load_dwordx4 v38, s[20:23], s5 offen nt lds
    s_add_u32 m0, s31, 43008
    s_nop 0
    buffer_load_dwordx4 v39, s[20:23], s5 offen nt lds
    s_add_u32 m0, s31, 44032
    s_nop 0
    buffer_load_dwordx4 v40, s[20:23], s5 offen nt lds
L_wdone_6:
    s_getpc_b64 s[92:93]
L_pc_7:
    s_add_u32 s92, s92, L_tail0-L_pc_7
    s_addc_u32 s93, s93, 0
    s_lshl_b32 s28, s3, 10
    v_lshlrev_b32 v50, 4, v0
    v_add_u32 v50, s28, v50
    s_mov_b32 s29, L_code_end-L_tail0-16
    v_min_u32 v51, s29, v50
    global_load_dwordx4 v[46:49], v51, s[92:93]
    v_add_u32 v50, 4096, v50
    v_min_u32 v51, s29, v50
    global_load_dwordx4 v[46:49], v51, s[92:93]
    v_add_u32 v50, 4096, v50
L_now:
L_tail0:
    s_waitcnt vmcnt(0) lgkmcnt(0)
    s_barrier
L_tail_dry:
    s_cmp_lg_u32 s3, 0
    s_cbranch_scc1 L_nomerge
    v_and_b32 v38, 31, v0
    v_lshlrev_b32 v38, 4, v38
    v_mov_b32 v39, 0
    ds_read_b128 v[204:207], v39 offset:13568
    ds_read_b128 v[208:211], v39 offset:13584
    ds_read_b128 v[212:215], v39 offset:13600
    ds_read_b128 v[216:219], v39 offset:13616
    ds_read_b128 v[172:175], v38 offset:9472
    ds_read_b128 v[176:179], v38 offset:9984
    ds_read_b128 v[180:183], v38 offset:10496
    ds_read_b128 v[184:187], v38 offset:11008
    ds_read_b128 v[188:191], v38 offset:11520
    ds_read_b128 v[192:195], v38 offset:12032
    ds_read_b128 v[196:199], v38 offset:12544
    ds_read_b128 v[200:203], v38 offset:13056
    s_waitcnt lgkmcnt(8)
    v_max3_f32 v40, v204, v206, v208
    v_max3_f32 v40, v40, v210, v212
    v_max3_f32 v40, v40, v214, v216
    v_max_f32 v40, v40, v218
    v_sub_f32 v204, v204, v40
    v_sub_f32 v206, v206, v40
    v_sub_f32 v208, v208, v40
    v_sub_f32 v210, v210, v40
    v_sub_f32 v212, v212, v40
    v_sub_f32 v214, v214, v40
    v_sub_f32 v216, v216, v40
    v_sub_f32 v218, v218, v40
    v_mul_f32 v204, s68, v204
    v_mul_f32 v206, s68, v206
    v_mul_f32 v208, s68, v208
    v_mul_f32 v210, s68, v210
    v_mul_f32 v212, s68, v212
    v_mul_f32 v214, s68, v214
    v_mul_f32 v216, s68, v216
    v_mul_f32 v218, s68, v218
    v_exp_f32 v204, v204
    v_exp_f32 v206, v206
    v_exp_f32 v208, v208
    v_exp_f32 v210, v210
    v_exp_f32 v212, v212
    v_exp_f32 v214, v214
    v_exp_f32 v216, v216
    v_exp_f32 v218, v218
    s_nop 0
    v_mul_f32 v41, v204, v205
    v_fmac_f32 v41, v206, v207
    v_fmac_f32 v41, v208, v209
    v_fmac_f32 v41, v210, v211
    v_fmac_f32 v41, v212, v213
    v_fmac_f32 v41, v214, v215
    v_fmac_f32 v41, v216, v217
    v_fmac_f32 v41, v218, v219
    s_waitcnt lgkmcnt(0)
    v_mul_f32 v44, v204, v172
    v_mul_f32 v45, v204, v173
    v_mul_f32 v46, v204, v174
    v_mul_f32 v47, v204, v175
    v_fmac_f32 v44, v206, v176
    v_fmac_f32 v45, v206, v177
    v_fmac_f32 v46, v206, v178
    v_fmac_f32 v47, v206, v179
    v_fmac_f32 v44, v208, v180
    v_fmac_f32 v45, v208, v181
    v_fmac_f32 v46, v208, v182
    v_fmac_f32 v47, v208, v183
    v_fmac_f32 v44, v210, v184
    v_fmac_f32 v45, v210, v185
    v_fmac_f32 v46, v210, v186
    v_fmac_f32 v47, v210, v187
    v_fmac_f32 v44, v212, v188
    v_fmac_f32 v45, v212, v189
    v_fmac_f32 v46, v212, v190
    v_fmac_f32 v47, v212, v191
    v_fmac_f32 v44, v214, v192
    v_fmac_f32 v45, v214, v193
    v_fmac_f32 v46, v214, v194
    v_fmac_f32 v47, v214, v195
    v_fmac_f32 v44, v216, v196
    v_fmac_f32 v45, v216, v197
    v_fmac_f32 v46, v216, v198
    v_fmac_f32 v47, v216, v199
    v_fmac_f32 v44, v218, v200
    v_fmac_f32 v45, v218, v201
    v_fmac_f32 v46, v218, v202
    v_fmac_f32 v47, v218, v203
    v_cmp_eq_u32 vcc, 32, v0
    v_mov_b32 v42, 0
    s_nop 0
    v_cndmask_b32 v44, v44, v40, vcc
    v_cndmask_b32 v45, v45, v41, vcc
    v_cndmask_b32 v46, v46, v42, vcc
    v_cndmask_b32 v47, v47, v42, vcc
    v_bfi_b32 v44, v37, v36, v44
    v_bfi_b32 v45, v37, v36, v45
    v_bfi_b32 v46, v37, v36, v46
    v_bfi_b32 v47, v37, v36, v47
    v_lshlrev_b32 v38, 4, v0
    s_mul_i32 s28, s57, 640
    s_add_u32 s28, s28, 655360
    v_cmp_gt_u32 vcc, 33, v0
    s_and_saveexec_b64 s[30:31], vcc
    buffer_store_dwordx4 v[44:47], v38, s[16:19], s28 offen sc1
    s_mov_b64 exec, s[30:31]
L_nomerge:
    s_cmp_eq_u32 s96, 0
    s_cbranch_scc1 L_stageB
    s_cmp_eq_u32 s96, 2
    s_cbranch_scc1 L_reduce
    s_mov_b32 s29, s97
    s_mul_i32 s59, s29, 21846
    s_lshr_b32 s59, s59, 16
    s_mul_i32 s31, s59, 3
    s_sub_u32 s60, s29, s31
    v_lshrrev_b32 v38, 2, v1
    v_lshl_add_u32 v38, v2, 3, v38
    v_mul_u32_u24 v38, 384, v38
    v_and_b32 v39, 3, v0
    v_lshl_add_u32 v38, v39, 3, v38
    s_lshl_b32 s28, s3, 5
    s_add_u32 s28, s28, 32768
    v_add_u32 v38, s28, v38
    ds_read_b64_tr_b16 v[64:65], v38 offset:0
    ds_read_b64_tr_b16 v[66:67], v38 offset:1536
    ds_read_b64_tr_b16 v[68:69], v38 offset:12288
    ds_read_b64_tr_b16 v[70:71], v38 offset:13824
    ds_read_b64_tr_b16 v[72:73], v38 offset:24576
    ds_read_b64_tr_b16 v[74:75], v38 offset:26112
    ds_read_b64_tr_b16 v[76:77], v38 offset:36864
    ds_read_b64_tr_b16 v[78:79], v38 offset:38400
    s_cmp_ge_u32 s3, 4
    s_cbranch_scc1 L_wo_gather_skip
    s_waitcnt lgkmcnt(0)
    ds_read_b64_tr_b16 v[80:81], v38 offset:256
    ds_read_b64_tr_b16 v[82:83], v38 offset:1792
    ds_read_b64_tr_b16 v[84:85], v38 offset:12544
    ds_read_b64_tr_b16 v[86:87], v38 offset:14080
    ds_read_b64_tr_b16 v[88:89], v38 offset:24832
    ds_read_b64_tr_b16 v[90:91], v38 offset:26368
    ds_read_b64_tr_b16 v[92:93], v38 offset:37120
    ds_read_b64_tr_b16 v[94:95], v38 offset:38656
    v_lshrrev_b32 v39, 5, v0
    v_mul_u32_u24 v40, 5120, v39
    v_and_b32 v41, 31, v0
    v_lshl_add_u32 v42, v41, 4, v40
    v_add_u32 v43, 512, v40
    s_and_b32 s28, s59, 7
    s_lshl_b32 s29, s3, 4
    s_add_u32 s28, s28, s29
    s_lshr_b32 s29, s59, 3
    s_lshl_b32 s29, s29, 6
    s_add_u32 s28, s28, s29
    s_mul_i32 s28, s28, 640
    s_add_u32 s28, s28, 655360
    buffer_load_dwordx4 v[96:99], v42, s[16:19], s28 offen sc1
    buffer_load_dwordx4 v[100:103], v43, s[16:19], s28 offen sc1
L_apoll:
    s_sub_u32 s61, s61, 1
    s_cbranch_scc1 L_end
    s_waitcnt vmcnt(0)
    v_xor_b32 v44, v96, v36
    v_bitop3_b32 v44, v44, v97, v36 bitop3:0xf6
    v_bitop3_b32 v44, v44, v98, v36 bitop3:0xf6
    v_bitop3_b32 v44, v44, v99, v36 bitop3:0xf6
    v_bitop3_b32 v44, v44, v100, v36 bitop3:0xf6
    v_bitop3_b32 v44, v44, v101, v36 bitop3:0xf6
    v_bitop3_b32 v44, v44, v102, v36 bitop3:0xf6
    v_bitop3_b32 v44, v44, v103, v36 bitop3:0xf6
    v_and_b32 v44, v44, v37
    v_cmp_ne_u32 vcc, 0, v44
    s_cbranch_vccz L_apoll_ok0
    buffer_load_dwordx4 v[96:99], v42, s[16:19], s28 offen sc1
    buffer_load_dwordx4 v[100:103], v43, s[16:19], s28 offen sc1
    s_branch L_apoll
L_apoll_ok0:
    v_mov_b32 v172, v96
    v_mov_b32 v173, v97
    v_mov_b32 v174, v98
    v_mov_b32 v175, v99
    v_mov_b32 v176, v100
    v_mov_b32 v177, v101
L_apoll_done:
    v_and_b32 v176, s70, v176
    v_mov_b32 v44, v176
    v_mov_b32 v45, v176
    s_nop 1
    v_permlane32_swap_b32 v44, v45
    s_nop 1
    v_max_f32 v44, v44, v45
    v_sub_f32 v176, v176, v44
    v_mul_f32 v176, s68, v176
    v_exp_f32 v176, v176
    s_nop 0
    v_mul_f32 v177, v177, v176
    v_mul_f32 v172, v172, v176
    v_mul_f32 v173, v173, v176
    v_mul_f32 v174, v174, v176
    v_mul_f32 v175, v175, v176
    v_mov_b32 v180, v172
    v_mov_b32 v181, v173
    v_mov_b32 v182, v174
    v_mov_b32 v183, v175
    v_mov_b32 v184, v177
    s_nop 1
    v_permlane32_swap_b32 v172, v180
    v_permlane32_swap_b32 v173, v181
    v_permlane32_swap_b32 v174, v182
    v_permlane32_swap_b32 v175, v183
    v_permlane32_swap_b32 v177, v184
    s_nop 1
    v_add_f32 v172, v172, v180
    v_add_f32 v173, v173, v181
    v_add_f32 v174, v174, v182
    v_add_f32 v175, v175, v183
    v_add_f32 v177, v177, v184
    v_rcp_f32 v44, v177
    s_nop 0
    v_mul_f32 v180, v172, v44
    v_fma_f32 v45, -v180, v177, v172
    v_fma_f32 v180, v45, v44, v180
    v_mul_f32 v181, v173, v44
    v_fma_f32 v45, -v181, v177, v173
    v_fma_f32 v181, v45, v44, v181
    v_mul_f32 v182, v174, v44
    v_fma_f32 v45, -v182, v177, v174
    v_fma_f32 v182, v45, v44, v182
    v_mul_f32 v183, v175, v44
    v_fma_f32 v45, -v183, v177, v175
    v_fma_f32 v183, v45, v44, v183
    v_cvt_pk_bf16_f32 v184, v180, v181
    v_cvt_pk_bf16_f32 v185, v182, v183
    v_lshlrev_b32 v41, 3, v41
    s_lshl_b32 s28, s3, 8
    v_add_u32 v41, s28, v41
    ds_write_b64 v41, v[184:185] offset:13632
L_wo_gather_skip:
    s_waitcnt lgkmcnt(0)
    s_barrier
    v_and_b32 v38, 3, v1
    v_lshlrev_b32 v38, 8, v38
    v_lshl_add_u32 v38, v2, 4, v38
    ds_read_b128 v[188:191], v38 offset:13632
    ds_read_b128 v[192:195], v38 offset:13696
    ds_read_b128 v[196:199], v38 offset:13760
    ds_read_b128 v[200:203], v38 offset:13824
    s_waitcnt lgkmcnt(0)
    v_mfma_f32_16x16x32_bf16 v[204:207], v[188:191], v[64:67], 0
    v_mfma_f32_16x16x32_bf16 v[204:207], v[192:195], v[68:71], v[204:207]
    v_mfma_f32_16x16x32_bf16 v[204:207], v[196:199], v[72:75], v[204:207]
    v_mfma_f32_16x16x32_bf16 v[204:207], v[200:203], v[76:79], v[204:207]
    s_cmp_ge_u32 s3, 4
    s_cbranch_scc1 L_wo_one
    v_mfma_f32_16x16x32_bf16 v[208:211], v[188:191], v[80:83], 0
    v_mfma_f32_16x16x32_bf16 v[208:211], v[192:195], v[84:87], v[208:211]
    v_mfma_f32_16x16x32_bf16 v[208:211], v[196:199], v[88:91], v[208:211]
    v_mfma_f32_16x16x32_bf16 v[208:211], v[200:203], v[92:95], v[208:211]
L_wo_one:
    s_mul_i32 s28, s59, 9216
    s_mul_i32 s29, s60, 3072
    s_add_u32 s28, s28, s29
    s_lshl_b32 s29, s3, 8
    s_add_u32 s28, s28, s29
    s_add_u32 s28, s28, 851968
    s_add_u32 s30, s28, 2048
    v_lshlrev_b32 v38, 4, v1
    s_nop 7
    v_bfi_b32 v204, v37, v36, v204
    v_bfi_b32 v205, v37, v36, v205
    v_bfi_b32 v206, v37, v36, v206
    v_bfi_b32 v207, v37, v36, v207
    s_mov_b64 exec, 0xffff
    buffer_store_dwordx4 v[204:207], v38, s[16:19], s28 offen sc1
    s_mov_b64 exec, -1
    s_cmp_ge_u32 s3, 4
    s_cbranch_scc1 L_reduce
    v_bfi_b32 v208, v37, v36, v208
    v_bfi_b32 v209, v37, v36, v209
    v_bfi_b32 v210, v37, v36, v210
    v_bfi_b32 v211, v37, v36, v211
    s_mov_b64 exec, 0xffff
    buffer_store_dwordx4 v[208:211], v38, s[16:19], s30 offen sc1
    s_mov_b64 exec, -1
L_reduce:
    s_mov_b32 s72, s97
    s_mul_i32 s28, s3, 112
    s_add_u32 s72, s72, s28
    s_cmp_ge_u32 s72, 144
    s_cbranch_scc1 L_fin
    s_cmp_ge_u32 s3, 2
    s_cbranch_scc1 L_fin
    v_and_b32 v38, 3, v0
    v_lshlrev_b32 v39, 1, v38
    v_lshrrev_b32 v40, 2, v0
    v_mul_u32_u24 v40, 9216, v40
    v_lshl_add_u32 v40, v38, 4, v40
    v_lshlrev_b32 v43, 4, v0
    s_lshl_b32 s28, s72, 6
    s_add_u32 s28, s28, 851968
    s_add_u32 s29, s28, 147456
    s_mov_b64 exec, 1
L_ypoll_probe:
    s_sub_u32 s61, s61, 1
    s_cbranch_scc1 L_end
    buffer_load_dword v232, v40, s[16:19], s28 offen sc1
    s_waitcnt vmcnt(0)
    v_xor_b32 v41, v232, v36
    v_and_b32 v41, v41, v37
    v_cmp_ne_u32 vcc, 0, v41
    s_cbranch_vccnz L_ypoll_probe
    s_mov_b64 exec, -1
    buffer_load_dwordx4 v[232:235], v40, s[16:19], s28 offen sc1
    buffer_load_dwordx4 v[236:239], v40, s[16:19], s29 offen sc1
L_ypoll:
    s_sub_u32 s61, s61, 1
    s_cbranch_scc1 L_end
    s_waitcnt vmcnt(0)
    v_xor_b32 v41, v232, v36
    v_bitop3_b32 v41, v41, v233, v36 bitop3:0xf6
    v_bitop3_b32 v41, v41, v234, v36 bitop3:0xf6
    v_bitop3_b32 v41, v41, v235, v36 bitop3:0xf6
    v_bitop3_b32 v41, v41, v236, v36 bitop3:0xf6
    v_bitop3_b32 v41, v41, v237, v36 bitop3:0xf6
    v_bitop3_b32 v41, v41, v238, v36 bitop3:0xf6
    v_bitop3_b32 v41, v41, v239, v36 bitop3:0xf6
    v_and_b32 v41, v41, v37
    v_cmp_ne_u32 vcc, 0, v41
    s_cbranch_vccz L_ypoll_ok0
    buffer_load_dwordx4 v[232:235], v40, s[16:19], s28 offen sc1
    buffer_load_dwordx4 v[236:239], v40, s[16:19], s29 offen sc1
    s_branch L_ypoll
L_ypoll_ok0:
    v_add_f32 v176, v232, v236
    v_add_f32 v177, v233, v237
    v_add_f32 v178, v234, v238
    v_add_f32 v179, v235, v239
L_ypoll_done:
    s_nop 1
    v_add_f32_dpp v176, v176, v176 row_ror:4 row_mask:0xf bank_mask:0xf
    v_add_f32_dpp v177, v177, v177 row_ror:4 row_mask:0xf bank_mask:0xf
    v_add_f32_dpp v178, v178, v178 row_ror:4 row_mask:0xf bank_mask:0xf
    v_add_f32_dpp v179, v179, v179 row_ror:4 row_mask:0xf bank_mask:0xf
    v_add_f32_dpp v176, v176, v176 row_ror:8 row_mask:0xf bank_mask:0xf
    v_add_f32_dpp v177, v177, v177 row_ror:8 row_mask:0xf bank_mask:0xf
    v_add_f32_dpp v178, v178, v178 row_ror:8 row_mask:0xf bank_mask:0xf
    v_add_f32_dpp v179, v179, v179 row_ror:8 row_mask:0xf bank_mask:0xf
    v_mov_b32 v180, v176
    v_mov_b32 v181, v177
    v_mov_b32 v182, v178
    v_mov_b32 v183, v179
    s_nop 1
    v_permlane16_swap_b32 v176, v180
    v_permlane16_swap_b32 v177, v181
    v_permlane16_swap_b32 v178, v182
    v_permlane16_swap_b32 v179, v183
    s_nop 1
    v_add_f32 v176, v176, v180
    v_add_f32 v177, v177, v181
    v_add_f32 v178, v178, v182
    v_add_f32 v179, v179, v183
    v_mov_b32 v180, v176
    v_mov_b32 v181, v177
    v_mov_b32 v182, v178
    v_mov_b32 v183, v179
    s_nop 1
    v_permlane32_swap_b32 v176, v180
    v_permlane32_swap_b32 v177, v181
    v_permlane32_swap_b32 v178, v182
    v_permlane32_swap_b32 v179, v183
    s_nop 1
    v_add_f32 v176, v176, v180
    v_add_f32 v177, v177, v181
    v_add_f32 v178, v178, v182
    v_add_f32 v179, v179, v183
    v_cvt_pk_bf16_f32 v180, v176, v177
    v_cvt_pk_bf16_f32 v181, v178, v179
    v_lshlrev_b32 v176, 16, v180
    v_and_b32 v177, s70, v180
    v_lshlrev_b32 v178, 16, v181
    v_and_b32 v179, s70, v181
    v_lshlrev_b32 v160, 16, v160
    v_add_f32 v176, v176, v160
    v_lshlrev_b32 v161, 16, v161
    v_add_f32 v177, v177, v161
    v_lshlrev_b32 v162, 16, v162
    v_add_f32 v178, v178, v162
    v_lshlrev_b32 v163, 16, v163
    v_add_f32 v179, v179, v163
    v_cvt_pk_bf16_f32 v180, v176, v177
    v_cvt_pk_bf16_f32 v181, v178, v179
    v_lshlrev_b32 v176, 16, v180
    v_and_b32 v177, s70, v180
    v_lshlrev_b32 v178, 16, v181
    v_and_b32 v179, s70, v181
    v_mov_b32 v188, v176
    v_mov_b32 v189, v177
    v_mov_b32 v190, v178
    v_mov_b32 v191, v179
    v_bfi_b32 v176, v37, v36, v176
    v_bfi_b32 v177, v37, v36, v177
    v_bfi_b32 v178, v37, v36, v178
    v_bfi_b32 v179, v37, v36, v179
    s_lshl_b32 s28, s72, 6
    s_add_u32 s28, s28, 1179648
    v_lshlrev_b32 v41, 4, v38
    s_mov_b64 exec, 0xf
    buffer_store_dwordx4 v[176:179], v41, s[16:19], s28 offen sc1
    s_mov_b64 exec, -1
    s_lshl_b32 s28, s72, 6
    s_add_u32 s28, s28, 1245184
    s_mul_i32 s73, s72, 9216
    s_add_u32 s73, s73, s28
    s_add_u32 s4, s28, 0
    s_add_u32 s5, s28, 147456
    s_add_u32 s6, s28, 294912
    s_add_u32 s7, s28, 442368
    s_add_u32 s62, s28, 589824
    s_add_u32 s63, s28, 737280
    s_add_u32 s66, s28, 884736
    s_add_u32 s67, s28, 1032192
    s_add_u32 s71, s28, 1179648
    s_mov_b64 exec, 1
L_zpoll_probe:
    s_sub_u32 s61, s61, 1
    s_cbranch_scc1 L_end
    buffer_load_dword v64, v40, s[16:19], s73 offen sc1
    s_waitcnt vmcnt(0)
    v_xor_b32 v41, v64, v36
    v_and_b32 v41, v41, v37
    v_cmp_ne_u32 vcc, 0, v41
    s_cbranch_vccnz L_zpoll_probe
    s_mov_b64 exec, -1
    buffer_load_dwordx4 v[64:67], v40, s[16:19], s4 offen sc1
    buffer_load_dwordx4 v[68:71], v40, s[16:19], s5 offen sc1
    buffer_load_dwordx4 v[72:75], v40, s[16:19], s6 offen sc1
    buffer_load_dwordx4 v[76:79], v40, s[16:19], s7 offen sc1
    buffer_load_dwordx4 v[80:83], v40, s[16:19], s62 offen sc1
    buffer_load_dwordx4 v[84:87], v40, s[16:19], s63 offen sc1
    buffer_load_dwordx4 v[88:91], v40, s[16:19], s66 offen sc1
    buffer_load_dwordx4 v[92:95], v40, s[16:19], s67 offen sc1
    buffer_load_dwordx4 v[96:99], v40, s[16:19], s71 offen sc1
L_zpoll:
    s_sub_u32 s61, s61, 1
    s_cbranch_scc1 L_end
    s_waitcnt vmcnt(0)
    v_xor_b32 v41, v64, v36
    v_bitop3_b32 v41, v41, v65, v36 bitop3:0xf6
    v_bitop3_b32 v41, v41, v66, v36 bitop3:0xf6
    v_bitop3_b32 v41, v41, v67, v36 bitop3:0xf6
    v_bitop3_b32 v41, v41, v68, v36 bitop3:0xf6
    v_bitop3_b32 v41, v41, v69, v36 bitop3:0xf6
    v_bitop3_b32 v41, v41, v70, v36 bitop3:0xf6
    v_bitop3_b32 v41, v41, v71, v36 bitop3:0xf6
    v_bitop3_b32 v41, v41, v72, v36 bitop3:0xf6
    v_bitop3_b32 v41, v41, v73, v36 bitop3:0xf6
    v_bitop3_b32 v41, v41, v74, v36 bitop3:0xf6
    v_bitop3_b32 v41, v41, v75, v36 bitop3:0xf6
    v_bitop3_b32 v41, v41, v76, v36 bitop3:0xf6
    v_bitop3_b32 v41, v41, v77, v36 bitop3:0xf6
    v_bitop3_b32 v41, v41, v78, v36 bitop3:0xf6
    v_bitop3_b32 v41, v41, v79, v36 bitop3:0xf6
    v_bitop3_b32 v41, v41, v80, v36 bitop3:0xf6
    v_bitop3_b32 v41, v41, v81, v36 bitop3:0xf6
    v_bitop3_b32 v41, v41, v82, v36 bitop3:0xf6
    v_bitop3_b32 v41, v41, v83, v36 bitop3:0xf6
    v_bitop3_b32 v41, v41, v84, v36 bitop3:0xf6
    v_bitop3_b32 v41, v41, v85, v36 bitop3:0xf6
    v_bitop3_b32 v41, v41, v86, v36 bitop3:0xf6
    v_bitop3_b32 v41, v41, v87, v36 bitop3:0xf6
    v_bitop3_b32 v41, v41, v88, v36 bitop3:0xf6
    v_bitop3_b32 v41, v41, v89, v36 bitop3:0xf6
    v_bitop3_b32 v41, v41, v90, v36 bitop3:0xf6
    v_bitop3_b32 v41, v41, v91, v36 bitop3:0xf6
    v_bitop3_b32 v41, v41, v92, v36 bitop3:0xf6
    v_bitop3_b32 v41, v41, v93, v36 bitop3:0xf6
    v_bitop3_b32 v41, v41, v94, v36 bitop3:0xf6
    v_bitop3_b32 v41, v41, v95, v36 bitop3:0xf6
    v_bitop3_b32 v41, v41, v96, v36 bitop3:0xf6
    v_bitop3_b32 v41, v41, v97, v36 bitop3:0xf6
    v_bitop3_b32 v41, v41, v98, v36 bitop3:0xf6
    v_bitop3_b32 v41, v41, v99, v36 bitop3:0xf6
    v_and_b32 v41, v41, v37
    v_cmp_ne_u32 vcc, 0, v41
    s_cbranch_vccz L_zpoll_ok0
    buffer_load_dwordx4 v[64:67], v40, s[16:19], s4 offen sc1
    buffer_load_dwordx4 v[68:71], v40, s[16:19], s5 offen sc1
    buffer_load_dwordx4 v[72:75], v40, s[16:19], s6 offen sc1
    buffer_load_dwordx4 v[76:79], v40, s[16:19], s7 offen sc1
    buffer_load_dwordx4 v[80:83], v40, s[16:19], s62 offen sc1
    buffer_load_dwordx4 v[84:87], v40, s[16:19], s63 offen sc1
    buffer_load_dwordx4 v[88:91], v40, s[16:19], s66 offen sc1
    buffer_load_dwordx4 v[92:95], v40, s[16:19], s67 offen sc1
    buffer_load_dwordx4 v[96:99], v40, s[16:19], s71 offen sc1
    s_branch L_zpoll
L_zpoll_ok0:
    v_pk_add_f32 v[64:65], v[64:65], v[68:69]
    v_pk_add_f32 v[66:67], v[66:67], v[70:71]
    v_pk_add_f32 v[72:73], v[72:73], v[76:77]
    v_pk_add_f32 v[74:75], v[74:75], v[78:79]
    v_pk_add_f32 v[80:81], v[80:81], v[84:85]
    v_pk_add_f32 v[82:83], v[82:83], v[86:87]
    v_pk_add_f32 v[88:89], v[88:89], v[92:93]
    v_pk_add_f32 v[90:91], v[90:91], v[94:95]
    v_pk_add_f32 v[64:65], v[64:65], v[72:73]
    v_pk_add_f32 v[66:67], v[66:67], v[74:75]
    v_pk_add_f32 v[80:81], v[80:81], v[88:89]
    v_pk_add_f32 v[82:83], v[82:83], v[90:91]
    v_pk_add_f32 v[64:65], v[64:65], v[80:81]
    v_pk_add_f32 v[66:67], v[66:67], v[82:83]
    v_pk_add_f32 v[192:193], v[64:65], v[96:97]
    v_pk_add_f32 v[194:195], v[66:67], v[98:99]
L_zpoll_done:
    s_nop 1
    v_add_f32_dpp v192, v192, v192 row_ror:4 row_mask:0xf bank_mask:0xf
    v_add_f32_dpp v193, v193, v193 row_ror:4 row_mask:0xf bank_mask:0xf
    v_add_f32_dpp v194, v194, v194 row_ror:4 row_mask:0xf bank_mask:0xf
    v_add_f32_dpp v195, v195, v195 row_ror:4 row_mask:0xf bank_mask:0xf
    v_add_f32_dpp v192, v192, v192 row_ror:8 row_mask:0xf bank_mask:0xf
    v_add_f32_dpp v193, v193, v193 row_ror:8 row_mask:0xf bank_mask:0xf
    v_add_f32_dpp v194, v194, v194 row_ror:8 row_mask:0xf bank_mask:0xf
    v_add_f32_dpp v195, v195, v195 row_ror:8 row_mask:0xf bank_mask:0xf
    v_mov_b32 v196, v192
    v_mov_b32 v197, v193
    v_mov_b32 v198, v194
    v_mov_b32 v199, v195
    s_nop 1
    v_permlane16_swap_b32 v192, v196
    v_permlane16_swap_b32 v193, v197
    v_permlane16_swap_b32 v194, v198
    v_permlane16_swap_b32 v195, v199
    s_nop 1
    v_add_f32 v192, v192, v196
    v_add_f32 v193, v193, v197
    v_add_f32 v194, v194, v198
    v_add_f32 v195, v195, v199
    v_mov_b32 v196, v192
    v_mov_b32 v197, v193
    v_mov_b32 v198, v194
    v_mov_b32 v199, v195
    s_nop 1
    v_permlane32_swap_b32 v192, v196
    v_permlane32_swap_b32 v193, v197
    v_permlane32_swap_b32 v194, v198
    v_permlane32_swap_b32 v195, v199
    s_nop 1
    v_add_f32 v192, v192, v196
    v_add_f32 v193, v193, v197
    v_add_f32 v194, v194, v198
    v_add_f32 v195, v195, v199
    v_cvt_pk_bf16_f32 v196, v192, v193
    v_cvt_pk_bf16_f32 v197, v194, v195
    v_lshlrev_b32 v192, 16, v196
    v_and_b32 v193, s70, v196
    v_lshlrev_b32 v194, 16, v197
    v_and_b32 v195, s70, v197
    v_add_f32 v192, v192, v188
    v_add_f32 v193, v193, v189
    v_add_f32 v194, v194, v190
    v_add_f32 v195, v195, v191
    v_cvt_pk_bf16_f32 v196, v192, v193
    v_cvt_pk_bf16_f32 v197, v194, v195
    s_mov_b32 s20, s50
    s_and_b32 s21, s51, 0xffff
    s_mov_b32 s22, s95
    s_mov_b32 s23, 0x00020000
    s_lshl_b32 s28, s72, 3
    s_mov_b64 exec, 0xf
    buffer_store_short v196, v39, s[20:23], s28 offen sc1
    buffer_store_short_d16_hi v196, v39, s[20:23], s28 offen offset:1152 sc1
    buffer_store_short v197, v39, s[20:23], s28 offen offset:2304 sc1
    buffer_store_short_d16_hi v197, v39, s[20:23], s28 offen offset:3456 sc1
    s_mov_b64 exec, -1
    s_cmp_lg_u32 s72, 0
    s_cbranch_scc1 L_fin
    v_mov_b32 v198, s56
    v_mov_b32 v199, 0
    s_mov_b64 exec, 1
    buffer_store_dword v198, v199, s[16:19], 0 offen sc1
    s_mov_b64 exec, -1
    s_branch L_fin
L_stageB:
    s_cmp_lg_u32 s3, 1
    s_cbranch_scc1 L_gate_done
    s_andn2_b32 s29, s57, 16
    v_mul_u32_u24 v38, 37, v0
    v_add_u32 v38, s29, v38
    v_and_b32 v38, 255, v38
    s_xor_b32 s28, s57, 16
    v_mov_b32 v39, s28
    v_cmp_eq_u32 vcc, 0, v0
    s_mov_b32 s28, 655872
    s_nop 0
    v_cndmask_b32 v38, v38, v39, vcc
    v_mul_u32_u24 v38, 640, v38
    s_mov_b64 exec, 0x1
L_gpoll:
    s_sub_u32 s61, s61, 1
    s_cbranch_scc1 L_end
    buffer_load_dword v40, v38, s[16:19], s28 offen sc1
    s_waitcnt vmcnt(0)
    v_xor_b32 v44, v40, v36
    v_and_b32 v44, v44, v37
    v_cmp_ne_u32 vcc, 0, v44
    s_cbranch_vccnz L_gpoll
    s_mov_b64 exec, -1
L_gate_done:
    s_barrier
    s_cmp_lg_u32 s3, 7
    s_cbranch_scc1 L_noones
    v_mov_b32 v172, 0x3f803f80
    v_mov_b32 v173, 0x3f803f80
    v_mov_b32 v174, 0x3f803f80
    v_mov_b32 v175, 0x3f803f80
    v_lshlrev_b32 v38, 4, v0
    ds_write_b128 v38, v[172:175] offset:19264
    s_mov_b64 exec, 0xff
    ds_write_b128 v38, v[172:175] offset:20288
    s_mov_b64 exec, -1
L_noones:
    s_cmp_lt_u32 s3, 4
    s_cbranch_scc1 L_b_noload
    s_mov_b32 s29, s98
    v_lshrrev_b32 v38, 2, v0
    v_mul_u32_u24 v38, 9216, v38
    v_and_b32 v39, 3, v0
    v_lshl_add_u32 v38, v39, 4, v38
    v_lshlrev_b32 v39, 4, v0
    s_and_b32 s73, s3, 3
    s_mov_b32 s20, s44
    s_and_b32 s21, s45, 0xffff
    s_mov_b32 s22, 5308416
    s_mov_b32 s23, 0x00020000
    s_mul_i32 s28, s73, 1327104
    s_lshl_b32 s30, s29, 6
    s_add_u32 s28, s28, s30
    s_mul_i32 s31, s73, 9216
    s_add_u32 m0, s31, 32768
    s_nop 0
    buffer_load_dwordx4 v38, s[20:23], s28 offen nt lds
    s_add_u32 s28, s28, 147456
    s_add_u32 m0, s31, 33792
    s_nop 0
    buffer_load_dwordx4 v38, s[20:23], s28 offen nt lds
    s_add_u32 s28, s28, 147456
    s_add_u32 m0, s31, 34816
    s_nop 0
    buffer_load_dwordx4 v38, s[20:23], s28 offen nt lds
    s_add_u32 s28, s28, 147456
    s_add_u32 m0, s31, 35840
    s_nop 0
    buffer_load_dwordx4 v38, s[20:23], s28 offen nt lds
    s_add_u32 s28, s28, 147456
    s_add_u32 m0, s31, 36864
    s_nop 0
    buffer_load_dwordx4 v38, s[20:23], s28 offen nt lds
    s_add_u32 s28, s28, 147456
    s_add_u32 m0, s31, 37888
    s_nop 0
    buffer_load_dwordx4 v38, s[20:23], s28 offen nt lds
    s_add_u32 s28, s28, 147456
    s_add_u32 m0, s31, 38912
    s_nop 0
    buffer_load_dwordx4 v38, s[20:23], s28 offen nt lds
    s_add_u32 s28, s28, 147456
    s_add_u32 m0, s31, 39936
    s_nop 0
    buffer_load_dwordx4 v38, s[20:23], s28 offen nt lds
    s_add_u32 s28, s28, 147456
    s_add_u32 m0, s31, 40960
    s_nop 0
    buffer_load_dwordx4 v38, s[20:23], s28 offen nt lds
    s_add_u32 s28, s28, 147456
    s_mov_b32 s20, s46
    s_and_b32 s21, s47, 0xffff
    s_mov_b32 s22, 5308416
    s_mov_b32 s23, 0x00020000
    s_mul_i32 s28, s73, 1327104
    s_lshl_b32 s30, s29, 6
    s_add_u32 s28, s28, s30
    s_mul_i32 s31, s73, 9216
    s_add_u32 m0, s31, 69632
    s_nop 0
    buffer_load_dwordx4 v38, s[20:23], s28 offen nt lds
    s_add_u32 s28, s28, 147456
    s_add_u32 m0, s31, 70656
    s_nop 0
    buffer_load_dwordx4 v38, s[20:23], s28 offen nt lds
    s_add_u32 s28, s28, 147456
    s_add_u32 m0, s31, 71680
    s_nop 0
    buffer_load_dwordx4 v38, s[20:23], s28 offen nt lds
    s_add_u32 s28, s28, 147456
    s_add_u32 m0, s31, 72704
    s_nop 0
    buffer_load_dwordx4 v38, s[20:23], s28 offen nt lds
    s_add_u32 s28, s28, 147456
    s_add_u32 m0, s31, 73728
    s_nop 0
    buffer_load_dwordx4 v38, s[20:23], s28 offen nt lds
    s_add_u32 s28, s28, 147456
    s_add_u32 m0, s31, 74752
    s_nop 0
    buffer_load_dwordx4 v38, s[20:23], s28 offen nt lds
    s_add_u32 s28, s28, 147456
    s_add_u32 m0, s31, 75776
    s_nop 0
    buffer_load_dwordx4 v38, s[20:23], s28 offen nt lds
    s_add_u32 s28, s28, 147456
    s_add_u32 m0, s31, 76800
    s_nop 0
    buffer_load_dwordx4 v38, s[20:23], s28 offen nt lds
    s_add_u32 s28, s28, 147456
    s_add_u32 m0, s31, 77824
    s_nop 0
    buffer_load_dwordx4 v38, s[20:23], s28 offen nt lds
    s_add_u32 s28, s28, 147456
    s_mov_b32 s20, s48
    s_and_b32 s21, s49, 0xffff
    s_mov_b32 s22, 5308416
    s_mov_b32 s23, 0x00020000
    s_mul_i32 s28, s29, 36864
    s_mul_i32 s31, s73, 9216
    s_add_u32 s28, s28, s31
    s_add_u32 m0, s31, 106496
    s_nop 0
    buffer_load_dwordx4 v39, s[20:23], s28 offen nt lds
    s_add_u32 s28, s28, 1024
    s_add_u32 m0, s31, 107520
    s_nop 0
    buffer_load_dwordx4 v39, s[20:23], s28 offen nt lds
    s_add_u32 s28, s28, 1024
    s_add_u32 m0, s31, 108544
    s_nop 0
    buffer_load_dwordx4 v39, s[20:23], s28 offen nt lds
    s_add_u32 s28, s28, 1024
    s_add_u32 m0, s31, 109568
    s_nop 0
    buffer_load_dwordx4 v39, s[20:23], s28 offen nt lds
    s_add_u32 s28, s28, 1024
    s_add_u32 m0, s31, 110592
    s_nop 0
    buffer_load_dwordx4 v39, s[20:23], s28 offen nt lds
    s_add_u32 s28, s28, 1024
    s_add_u32 m0, s31, 111616
    s_nop 0
    buffer_load_dwordx4 v39, s[20:23], s28 offen nt lds
    s_add_u32 s28, s28, 1024
    s_add_u32 m0, s31, 112640
    s_nop 0
    buffer_load_dwordx4 v39, s[20:23], s28 offen nt lds
    s_add_u32 s28, s28, 1024
    s_add_u32 m0, s31, 113664
    s_nop 0
    buffer_load_dwordx4 v39, s[20:23], s28 offen nt lds
    s_add_u32 s28, s28, 1024
    s_add_u32 m0, s31, 114688
    s_nop 0
    buffer_load_dwordx4 v39, s[20:23], s28 offen nt lds
    s_add_u32 s28, s28, 1024
L_b_noload:
    v_lshrrev_b32 v38, 2, v1
    v_lshl_add_u32 v38, v2, 3, v38
    v_and_b32 v39, 3, v0
    v_lshlrev_b32 v52, 6, v38
    v_lshl_add_u32 v52, v39, 3, v52
    s_and_b32 s28, s3, 1
    s_lshl_b32 s28, s28, 5
    s_bfe_u32 s29, s3, 0x10001
    s_mul_i32 s29, s29, 36864
    s_add_u32 s28, s28, s29
    s_add_u32 s28, s28, 32768
    s_lshr_b32 s29, s3, 2
    s_mul_i32 s29, s29, 18432
    s_add_u32 s28, s28, s29
    v_add_u32 v52, s28, v52
    v_mul_u32_u24 v53, 1152, v38
    v_lshl_add_u32 v53, v39, 3, v53
    s_lshl_b32 s28, s3, 7
    s_add_u32 s28, s28, 106496
    v_add_u32 v53, s28, v53
    s_lshl_b32 s28, s3, 8
    v_lshlrev_b32 v42, 1, v0
    v_add_u32 v42, s28, v42
    v_and_b32 v43, 3, v1
    v_cmp_eq_u32 vcc, 4, v1
    v_mov_b32 v44, 4
    s_lshr_b32 s28, s3, 2
    v_cndmask_b32 v43, v43, v44, vcc
    v_mul_u32_u24 v43, 1152, v43
    s_mul_i32 s28, s28, 576
    v_lshl_add_u32 v43, v2, 4, v43
    v_add_u32 v43, s28, v43
    s_lshl_b32 s28, s3, 10
    v_lshlrev_b32 v44, 4, v0
    v_add_u32 v44, s28, v44
    s_lshl_b32 s28, s3, 8
    v_lshlrev_b32 v45, 4, v1
    v_add_u32 v45, s28, v45
    v_lshrrev_b32 v49, 2, v0
    v_and_b32 v48, 3, v0
    s_lshl_b32 s28, s3, 10
    v_lshlrev_b32 v47, 4, v49
    v_add_u32 v47, s28, v47
    v_lshl_add_u32 v46, v48, 2, v47
    s_lshl_b32 s28, s3, 5
    v_lshlrev_b32 v49, 1, v49
    v_add_u32 v49, s28, v49
    v_lshl_add_u32 v49, v48, 6, v49
    v_lshlrev_b32 v38, 4, v48
    v_mov_b32 v39, 64
    v_and_b32 v40, 4, v0
    v_cmp_ne_u32 vcc, 0, v40
    v_lshrrev_b32 v40, 3, v0
    v_lshlrev_b32 v40, 8, v40
    v_cndmask_b32 v38, v38, v39, vcc
    v_lshl_add_u32 v48, v48, 2, v38
    v_add_u32 v48, v48, v40
    s_mov_b32 s64, 0xf0f0f0f0
    s_mov_b32 s65, 0xf0f0f0f0
    v_lshlrev_b32 v50, 4, v0
    s_cmp_ge_u32 s3, 4
    s_cbranch_scc1 L_b_loadwait
    s_lshl_b32 s28, s3, 11
    s_add_u32 s28, s28, 1179648
    s_add_u32 s29, s28, 1024
    s_mov_b32 s31, 1187840
    v_mov_b32 v228, v36
    v_mov_b32 v229, v36
    v_mov_b32 v230, v36
    v_mov_b32 v231, v36
    s_cmp_lg_u32 s3, 0
    s_cbranch_scc1 L_h1
    s_mov_b64 exec, 1
L_hpoll2_probe:
    s_sub_u32 s61, s61, 1
    s_cbranch_scc1 L_end
    buffer_load_dword v220, v50, s[16:19], s28 offen sc1
    s_waitcnt vmcnt(0)
    v_xor_b32 v51, v220, v36
    v_and_b32 v51, v51, v37
    v_cmp_ne_u32 vcc, 0, v51
    s_cbranch_vccnz L_hpoll2_probe
    s_mov_b64 exec, -1
    buffer_load_dwordx4 v[220:223], v50, s[16:19], s28 offen sc1
    buffer_load_dwordx4 v[224:227], v50, s[16:19], s29 offen sc1
    buffer_load_dwordx4 v[228:231], v50, s[16:19], s31 offen sc1
L_hpoll2:
    s_sub_u32 s61, s61, 1
    s_cbranch_scc1 L_end
    s_waitcnt vmcnt(0)
    v_xor_b32 v51, v220, v36
    v_bitop3_b32 v51, v51, v221, v36 bitop3:0xf6
    v_bitop3_b32 v51, v51, v222, v36 bitop3:0xf6
    v_bitop3_b32 v51, v51, v223, v36 bitop3:0xf6
    v_bitop3_b32 v51, v51, v224, v36 bitop3:0xf6
    v_bitop3_b32 v51, v51, v225, v36 bitop3:0xf6
    v_bitop3_b32 v51, v51, v226, v36 bitop3:0xf6
    v_bitop3_b32 v51, v51, v227, v36 bitop3:0xf6
    v_bitop3_b32 v51, v51, v228, v36 bitop3:0xf6
    v_bitop3_b32 v51, v51, v229, v36 bitop3:0xf6
    v_bitop3_b32 v51, v51, v230, v36 bitop3:0xf6
    v_bitop3_b32 v51, v51, v231, v36 bitop3:0xf6
    v_and_b32 v51, v51, v37
    v_cmp_ne_u32 vcc, 0, v51
    s_cbranch_vccz L_hpoll2_ok0
    buffer_load_dwordx4 v[220:223], v50, s[16:19], s28 offen sc1
    buffer_load_dwordx4 v[224:227], v50, s[16:19], s29 offen sc1
    buffer_load_dwordx4 v[228:231], v50, s[16:19], s31 offen sc1
    s_branch L_hpoll2
L_hpoll2_ok0:
    ds_write_b16_d16_hi v42, v220 offset:14656
    ds_write_b16_d16_hi v42, v224 offset:14784
    ds_write_b16_d16_hi v42, v221 offset:15808
    ds_write_b16_d16_hi v42, v225 offset:15936
    ds_write_b16_d16_hi v42, v222 offset:16960
    ds_write_b16_d16_hi v42, v226 offset:17088
    ds_write_b16_d16_hi v42, v223 offset:18112
    ds_write_b16_d16_hi v42, v227 offset:18240
    ds_write_b16_d16_hi v42, v228 offset:15680
    ds_write_b16_d16_hi v42, v229 offset:16832
    ds_write_b16_d16_hi v42, v230 offset:17984
    ds_write_b16_d16_hi v42, v231 offset:19136
L_hpoll2_done:
    s_branch L_h2
L_h1:
    s_mov_b64 exec, 1
L_hpoll1_probe:
    s_sub_u32 s61, s61, 1
    s_cbranch_scc1 L_end
    buffer_load_dword v220, v50, s[16:19], s28 offen sc1
    s_waitcnt vmcnt(0)
    v_xor_b32 v51, v220, v36
    v_and_b32 v51, v51, v37
    v_cmp_ne_u32 vcc, 0, v51
    s_cbranch_vccnz L_hpoll1_probe
    s_mov_b64 exec, -1
    buffer_load_dwordx4 v[220:223], v50, s[16:19], s28 offen sc1
    buffer_load_dwordx4 v[224:227], v50, s[16:19], s29 offen sc1
L_hpoll1:
    s_sub_u32 s61, s61, 1
    s_cbranch_scc1 L_end
    s_waitcnt vmcnt(0)
    v_xor_b32 v51, v220, v36
    v_bitop3_b32 v51, v51, v221, v36 bitop3:0xf6
    v_bitop3_b32 v51, v51, v222, v36 bitop3:0xf6
    v_bitop3_b32 v51, v51, v223, v36 bitop3:0xf6
    v_bitop3_b32 v51, v51, v224, v36 bitop3:0xf6
    v_bitop3_b32 v51, v51, v225, v36 bitop3:0xf6
    v_bitop3_b32 v51, v51, v226, v36 bitop3:0xf6
    v_bitop3_b32 v51, v51, v227, v36 bitop3:0xf6
    v_and_b32 v51, v51, v37
    v_cmp_ne_u32 vcc, 0, v51
    s_cbranch_vccz L_hpoll1_ok0
    buffer_load_dwordx4 v[220:223], v50, s[16:19], s28 offen sc1
    buffer_load_dwordx4 v[224:227], v50, s[16:19], s29 offen sc1
    s_branch L_hpoll1
L_hpoll1_ok0:
    ds_write_b16_d16_hi v42, v220 offset:14656
    ds_write_b16_d16_hi v42, v224 offset:14784
    ds_write_b16_d16_hi v42, v221 offset:15808
    ds_write_b16_d16_hi v42, v225 offset:15936
    ds_write_b16_d16_hi v42, v222 offset:16960
    ds_write_b16_d16_hi v42, v226 offset:17088
    ds_write_b16_d16_hi v42, v223 offset:18112
    ds_write_b16_d16_hi v42, v227 offset:18240
L_hpoll1_done:
    s_branch L_h2
L_b_loadwait:
    s_waitcnt vmcnt(0)
L_h2:
    s_waitcnt lgkmcnt(0)
    s_barrier
    ds_read_b64_tr_b16 v[64:65], v52 offset:0
    ds_read_b64_tr_b16 v[66:67], v52 offset:256
    ds_read_b128 v[172:175], v43 offset:14656
    ds_read_b64_tr_b16 v[68:69], v52 offset:2048
    ds_read_b64_tr_b16 v[70:71], v52 offset:2304
    ds_read_b128 v[176:179], v43 offset:14720
    ds_read_b64_tr_b16 v[72:73], v52 offset:4096
    ds_read_b64_tr_b16 v[74:75], v52 offset:4352
    ds_read_b128 v[180:183], v43 offset:14784
    ds_read_b64_tr_b16 v[76:77], v52 offset:6144
    ds_read_b64_tr_b16 v[78:79], v52 offset:6400
    ds_read_b128 v[184:187], v43 offset:14848
    s_waitcnt lgkmcnt(9)
    v_mfma_f32_16x16x32_bf16 v[212:215], v[172:175], v[64:67], 0
    ds_read_b64_tr_b16 v[80:81], v52 offset:8192
    ds_read_b64_tr_b16 v[82:83], v52 offset:8448
    ds_read_b128 v[188:191], v43 offset:14912
    s_waitcnt lgkmcnt(9)
    v_mfma_f32_16x16x32_bf16 v[212:215], v[176:179], v[68:71], v[212:215]
    ds_read_b64_tr_b16 v[84:85], v52 offset:10240
    ds_read_b64_tr_b16 v[86:87], v52 offset:10496
    ds_read_b128 v[192:195], v43 offset:14976
    s_waitcnt lgkmcnt(9)
    v_mfma_f32_16x16x32_bf16 v[212:215], v[180:183], v[72:75], v[212:215]
    ds_read_b64_tr_b16 v[88:89], v52 offset:12288
    ds_read_b64_tr_b16 v[90:91], v52 offset:12544
    ds_read_b128 v[196:199], v43 offset:15040
    s_waitcnt lgkmcnt(9)
    v_mfma_f32_16x16x32_bf16 v[212:215], v[184:187], v[76:79], v[212:215]
    ds_read_b64_tr_b16 v[92:93], v52 offset:14336
    ds_read_b64_tr_b16 v[94:95], v52 offset:14592
    ds_read_b128 v[200:203], v43 offset:15104
    s_waitcnt lgkmcnt(9)
    v_mfma_f32_16x16x32_bf16 v[212:215], v[188:191], v[80:83], v[212:215]
    ds_read_b64_tr_b16 v[96:97], v52 offset:16384
    ds_read_b64_tr_b16 v[98:99], v52 offset:16640
    ds_read_b128 v[204:207], v43 offset:15168
    s_waitcnt lgkmcnt(9)
    v_mfma_f32_16x16x32_bf16 v[212:215], v[192:195], v[84:87], v[212:215]
    s_waitcnt lgkmcnt(6)
    v_mfma_f32_16x16x32_bf16 v[212:215], v[196:199], v[88:91], v[212:215]
    s_waitcnt lgkmcnt(3)
    v_mfma_f32_16x16x32_bf16 v[212:215], v[200:203], v[92:95], v[212:215]
    s_waitcnt lgkmcnt(0)
    v_mfma_f32_16x16x32_bf16 v[212:215], v[204:207], v[96:99], v[212:215]
L_b_mmdone:
    ds_read_b64_tr_b16 v[100:101], v53 offset:0
    ds_read_b64_tr_b16 v[102:103], v53 offset:4608
    ds_read_b64_tr_b16 v[104:105], v53 offset:32
    ds_read_b64_tr_b16 v[106:107], v53 offset:4640
    ds_read_b64_tr_b16 v[108:109], v53 offset:64
    ds_read_b64_tr_b16 v[110:111], v53 offset:4672
    ds_read_b64_tr_b16 v[112:113], v53 offset:96
    ds_read_b64_tr_b16 v[114:115], v53 offset:4704
    s_cmp_ge_u32 s3, 4
    s_cbranch_scc1 L_no5th
    s_mul_i32 s28, s3, 96
    s_sub_u32 s28, 1024, s28
    v_add_u32 v54, s28, v53
    ds_read_b64_tr_b16 v[116:117], v54 offset:0
    ds_read_b64_tr_b16 v[118:119], v54 offset:4608
L_no5th:
    s_and_b32 s28, s3, 3
    s_cmp_eq_u32 s28, 1
    s_cbranch_scc1 L_gr_9
    s_cmp_eq_u32 s28, 2
    s_cbranch_scc1 L_gr_10
    s_cmp_eq_u32 s28, 3
    s_cbranch_scc1 L_gr_11
L_gr_8:
    v_mfma_f32_16x16x32_bf16 v[216:219], v[172:175], v[172:175], 0
    v_mfma_f32_16x16x32_bf16 v[216:219], v[188:191], v[188:191], v[216:219]
    v_mfma_f32_16x16x32_bf16 v[216:219], v[204:207], v[204:207], v[216:219]
    s_branch L_gre_12
L_gr_9:
    v_mfma_f32_16x16x32_bf16 v[216:219], v[176:179], v[176:179], 0
    v_mfma_f32_16x16x32_bf16 v[216:219], v[192:195], v[192:195], v[216:219]
    s_branch L_gre_12
L_gr_10:
    v_mfma_f32_16x16x32_bf16 v[216:219], v[180:183], v[180:183], 0
    v_mfma_f32_16x16x32_bf16 v[216:219], v[196:199], v[196:199], v[216:219]
    s_branch L_gre_12
L_gr_11:
    v_mfma_f32_16x16x32_bf16 v[216:219], v[184:187], v[184:187], 0
    v_mfma_f32_16x16x32_bf16 v[216:219], v[200:203], v[200:203], v[216:219]
L_gre_12:
    s_nop 2
    ds_write_b128 v44, v[212:215] offset:20416
    s_nop 6
    s_mov_b64 exec, 0xffff
    ds_write_b128 v45, v[216:219] offset:28608
    s_mov_b64 exec, -1
    s_waitcnt lgkmcnt(0)
    s_barrier
    s_cmp_ge_u32 s3, 2
    s_cbranch_scc1 L_nogelu
    ds_read_b32 v180, v48 offset:28608
    ds_read_b32 v172, v46 offset:20416
    ds_read_b32 v173, v46 offset:24512
    ds_read_b32 v174, v46 offset:22464
    ds_read_b32 v175, v46 offset:26560
    ds_read_b32 v176, v47 offset:20672
    ds_read_b32 v177, v47 offset:24768
    ds_read_b32 v178, v47 offset:22720
    ds_read_b32 v179, v47 offset:26816
    s_waitcnt lgkmcnt(8)
    s_nop 1
    v_add_f32_dpp v180, v180, v180 row_ror:8 row_mask:0xf bank_mask:0xf
    v_mov_b32 v182, v180
    s_nop 1
    v_permlane16_swap_b32 v180, v182
    s_nop 1
    v_add_f32 v180, v180, v182
    v_mov_b32 v182, v180
    s_nop 1
    v_permlane32_swap_b32 v180, v182
    s_nop 1
    v_add_f32 v180, v180, v182
    s_nop 1
    v_mov_b32_dpp v181, v180 row_ror:4 row_mask:0xf bank_mask:0xf
    s_nop 0
    v_cndmask_b32 v182, v181, v180, s[64:65]
    v_cndmask_b32 v181, v180, v181, s[64:65]
    v_mul_f32 v182, 987991609, v182
    v_mul_f32 v181, 987991609, v181
    v_fma_f32 v181, -v182, v182, v181
    v_max_f32 v181, 0, v181
    v_cvt_pk_bf16_f32 v180, v182, v181
    v_lshlrev_b32 v182, 16, v180
    v_and_b32 v181, s70, v180
    v_add_f32 v181, 925353388, v181
    v_cvt_pk_bf16_f32 v180, v181, v181
    v_lshlrev_b32 v181, 16, v180
    v_sqrt_f32 v181, v181
    s_nop 0
    v_cvt_pk_bf16_f32 v180, v181, v181
    v_lshlrev_b32 v181, 16, v180
    v_rcp_f32 v180, v181
    s_waitcnt lgkmcnt(0)
    v_add_f32 v172, v172, v173
    v_add_f32 v174, v174, v175
    v_add_f32 v176, v176, v177
    v_add_f32 v178, v178, v179
    v_fma_f32 v172, -v182, v176, v172
    v_fma_f32 v174, -v182, v178, v174
    v_mul_f32 v173, v172, v180
    v_fma_f32 v176, -v173, v181, v172
    v_fma_f32 v173, v176, v180, v173
    v_mul_f32 v175, v174, v180
    v_fma_f32 v177, -v175, v181, v174
    v_fma_f32 v175, v177, v180, v175
    v_cvt_pk_bf16_f32 v176, v173, v175
    v_lshlrev_b32 v173, 16, v176
    v_and_b32 v175, s70, v176
    v_mul_f32 v176, v173, v173
    v_mul_f32 v176, v176, v173
    v_mov_b32 v177, 1027024659
    v_fma_f32 v176, v176, v177, v173
    v_mul_f32 v176, 1061962282, v176
    v_mul_f32 v176, 1077455419, v176
    v_exp_f32 v176, v176
    v_mul_f32 v178, 0.5, v173
    v_add_f32 v176, 1.0, v176
    v_rcp_f32 v176, v176
    s_nop 0
    v_fma_f32 v176, -2.0, v176, 1.0
    v_add_f32 v176, 1.0, v176
    v_mul_f32 v173, v178, v176
    v_cvt_pk_bf16_f32 v176, v173, v173
    v_lshlrev_b32 v173, 16, v176
    v_mul_f32 v173, v173, v175
    v_cvt_pk_bf16_f32 v176, v173, v173
    ds_write_b16 v49, v176 offset:30656
    s_waitcnt lgkmcnt(0)
L_nogelu:
    s_barrier
    v_and_b32 v43, 3, v1
    v_lshlrev_b32 v43, 6, v43
    v_lshl_add_u32 v43, v2, 4, v43
    ds_read_b128 v[172:175], v43 offset:30656
    s_mul_i32 s28, s97, 9216
    s_add_u32 s28, s28, 1245184
    s_lshl_b32 s29, s3, 8
    s_add_u32 s28, s28, s29
    v_lshlrev_b32 v44, 4, v1
    s_waitcnt lgkmcnt(0)
    v_mfma_f32_16x16x32_bf16 v[180:183], v[172:175], v[100:103], 0
    v_mfma_f32_16x16x32_bf16 v[184:187], v[172:175], v[104:107], 0
    v_mfma_f32_16x16x32_bf16 v[188:191], v[172:175], v[108:111], 0
    v_mfma_f32_16x16x32_bf16 v[192:195], v[172:175], v[112:115], 0
    s_cmp_ge_u32 s3, 4
    s_cbranch_scc1 L_z4
    v_mfma_f32_16x16x32_bf16 v[196:199], v[172:175], v[116:119], 0
L_z4:
    s_mul_i32 s28, s97, 9216
    s_add_u32 s28, s28, 1245184
    s_lshl_b32 s29, s3, 10
    s_add_u32 s29, s29, s28
    v_lshlrev_b32 v44, 4, v0
    s_lshl_b32 s30, s3, 8
    s_add_u32 s30, s30, s28
    s_add_u32 s30, s30, 8192
    s_nop 1
    v_permlane16_swap_b32 v180, v184
    v_permlane16_swap_b32 v181, v185
    v_permlane16_swap_b32 v182, v186
    v_permlane16_swap_b32 v183, v187
    v_permlane16_swap_b32 v188, v192
    v_permlane16_swap_b32 v189, v193
    v_permlane16_swap_b32 v190, v194
    v_permlane16_swap_b32 v191, v195
    s_nop 1
    v_permlane32_swap_b32 v180, v188
    v_permlane32_swap_b32 v181, v189
    v_permlane32_swap_b32 v182, v190
    v_permlane32_swap_b32 v183, v191
    s_nop 1
    v_bfi_b32 v180, v37, v36, v180
    v_bfi_b32 v181, v37, v36, v181
    v_bfi_b32 v182, v37, v36, v182
    v_bfi_b32 v183, v37, v36, v183
    buffer_store_dwordx4 v[180:183], v44, s[16:19], s29 offen sc1
    s_cmp_ge_u32 s3, 4
    s_cbranch_scc1 L_fin
    v_bfi_b32 v196, v37, v36, v196
    v_bfi_b32 v197, v37, v36, v197
    v_bfi_b32 v198, v37, v36, v198
    v_bfi_b32 v199, v37, v36, v199
    s_mov_b64 exec, 0xffff
    buffer_store_dwordx4 v[196:199], v44, s[16:19], s30 offen sc1
    s_mov_b64 exec, -1
L_fin:
L_end:
    s_endpgm
L_code_end:
.section .rodata,"a"
.p2align 6
.amdhsa_kernel sequential_preLN__mha_block_cached__glu_gated_geglu__decode_kernel
  .amdhsa_next_free_vgpr 256
  .amdhsa_next_free_sgpr 102
  .amdhsa_accum_offset 256
  .amdhsa_group_segment_fixed_size 0
  .amdhsa_kernarg_size 96
  .amdhsa_user_sgpr_count 2
  .amdhsa_user_sgpr_kernarg_segment_ptr 1
  .amdhsa_system_sgpr_workgroup_id_x 1
.end_amdhsa_kernel
.text
```
